```python
import torch

def _softmax(x, axis=-1):
    return torch.softmax(x, dim=axis)
def _gelu(x):
    return torch.nn.functional.gelu(x, approximate="tanh")
def _silu(x):
    return torch.nn.functional.silu(x)
def _sigmoid(x):
    return torch.sigmoid(x)
def _layernorm(x, axis=-1, eps=1e-5):
    m = x.mean(dim=axis, keepdim=True)
    v = x.var(dim=axis, keepdim=True, unbiased=False)
    return (x - m) / torch.sqrt(v + eps)
def _scatter_add(tgt, idx, src, axis=0):
    return tgt.clone().index_add_(axis, idx, src)
def _segment_sum(src, seg, n):
    out = torch.zeros((n,) + src.shape[1:], dtype=src.dtype)
    return out.index_add_(0, seg, src)
def _pad(x, pw):
    flat = tuple(v for pair in reversed(pw) for v in pair)
    return torch.nn.functional.pad(x, flat)

kernel_name = 'parallel_sum__sliding_block_cached__glu_gated_reglu__decode'

def setup_inputs():

    _w = (lambda a: (lambda t: t.to(torch.bfloat16) if t.is_floating_point() else t)(torch.as_tensor(a)))
    def _A_setup():
        B, Sq, D = 2, 1, 448
        Hq, Hkv, Sk, Dh = 16, 8, 32768, 256
        assert Hq % Hkv == 0, (Hq, Hkv)
        return {
            "x": _w((lambda *s: torch.randn(*s, dtype=torch.bfloat16) * 0.05)(B, Sq, D)),
            "k_cache": _w((lambda *s: torch.randn(*s, dtype=torch.bfloat16) * 1.6)(B, Hkv, Sk, Dh)),
            "v_cache": _w((lambda *s: torch.randn(*s, dtype=torch.bfloat16) * 0.8)(B, Hkv, Sk, Dh)),
            "wq": _w((lambda *s: torch.randn(*s, dtype=torch.bfloat16) * 1.6)(D, Hq * Dh) * (D ** -0.5)),
            "wo": _w((lambda *s: torch.randn(*s, dtype=torch.bfloat16) * 0.8)(Hq * Dh, D) * ((Hq * Dh) ** -0.5)),
        }
    _A_in = _A_setup()

    def _B_setup():
        B, S, D, F = 2, 1, 448, 1792
        return {
            "x": _w((lambda *s: torch.randn(*s, dtype=torch.bfloat16) * 0.05)(B, S, D)),
            "W_gate": _w((lambda *s: torch.randn(*s, dtype=torch.bfloat16) * 0.4)(D, F) * (2.0 / D) ** 0.5),
            "W_up": _w((lambda *s: torch.randn(*s, dtype=torch.bfloat16) * 0.4)(D, F) * (2.0 / D) ** 0.5),
            "W_down": _w((lambda *s: torch.randn(*s, dtype=torch.bfloat16) * 0.4)(F, D) * (1.0 / F) ** 0.5),
        }
    _B_in = _B_setup()

    return {
        "A_x": _A_in["x"],
        "A_k_cache": _A_in["k_cache"],
        "A_v_cache": _A_in["v_cache"],
        "A_wq": _A_in["wq"],
        "A_wo": _A_in["wo"],
        "B_x": _B_in["x"],
        "B_W_gate": _B_in["W_gate"],
        "B_W_up": _B_in["W_up"],
        "B_W_down": _B_in["W_down"],
    }

def reference(A_x, A_k_cache, A_v_cache, A_wq, A_wo, B_x, B_W_gate, B_W_up, B_W_down):
    def _A_ref(x, k_cache, v_cache, wq, wo):
        B, Sq, D = x.shape
        Hq, Dh = 16, 256
        Hkv, Sk = k_cache.shape[1], k_cache.shape[2]
        W = min(4096, max(256, Sk // 4))
        rep = Hq // Hkv
        q = (lambda x, *d: x.permute(*d))((x @ wq).reshape(B, Sq, Hq, Dh), 0, 2, 1, 3)
        k = (lambda x, n, axis: torch.repeat_interleave(x, n, dim=axis))(k_cache[:, :, Sk - W:, :], rep, axis=1)
        v = (lambda x, n, axis: torch.repeat_interleave(x, n, dim=axis))(v_cache[:, :, Sk - W:, :], rep, axis=1)
        scores = torch.einsum("bhqd,bhkd->bhqk", q, k) * (Dh ** -0.5)
        p = _softmax(scores, axis=-1)
        o = torch.einsum("bhqk,bhkd->bhqd", p, v)
        return (lambda x, *d: x.permute(*d))(o, 0, 2, 1, 3).reshape(B, Sq, Hq * Dh) @ wo

    def _B_ref(x, W_gate, W_up, W_down):
        gate = torch.einsum("bsd,df->bsf", x, W_gate)
        up = torch.einsum("bsd,df->bsf", x, W_up)
        gate = gate * (lambda x, dt: x.to(dt))(gate > 0, gate.dtype)
        h = gate * up
        return torch.einsum("bsf,fd->bsd", h, W_down)

    x = A_x
    xn = _layernorm(x, axis=-1)
    return x + _A_ref(xn, A_k_cache, A_v_cache, A_wq, A_wo) + _B_ref(xn, B_W_gate, B_W_up, B_W_down)
```

```asm
; @launch grid=(256,1,1) block=(768,1,1) lds=163840
.amdgcn_target "amdgcn-amd-amdhsa--gfx950"
.text
.globl parallel_sum__sliding_block_cached__glu_gated_reglu__decode_kernel
.p2align 8
.type parallel_sum__sliding_block_cached__glu_gated_reglu__decode_kernel,@function
parallel_sum__sliding_block_cached__glu_gated_reglu__decode_kernel:
    s_load_dwordx16 s[4:19], s[0:1], 0
    s_load_dwordx8 s[20:27], s[0:1], 64
    s_cmpk_ge_u32 s2, 0x100
    s_cbranch_scc1 L_exit
    v_lshrrev_b32 v1, 6, v0
    v_and_b32 v0, 63, v0
    v_readfirstlane_b32 s3, v1
    s_and_b32 s28, s2, 7
    s_cmp_eq_u32 s3, 0
    s_cbranch_scc1 L_w0
    s_cmp_eq_u32 s3, 1
    s_cbranch_scc1 L_w1
    s_cmp_lt_u32 s3, 4
    s_cbranch_scc1 L_w23
    s_sub_u32 s53, s3, 4
    s_lshl_b32 m0, s53, 14
    s_lshl4_add_u32 s54, s2, s3
    s_mul_i32 s54, s54, 0x9E3779B1
    s_lshr_b32 s54, s54, 28
    s_lshr_b32 s55, s2, 7
    s_lshl3_add_u32 s55, s55, s28
    s_lshl_b32 s55, s55, 24
    s_and_b32 s56, s2, 0x78
    s_add_u32 s56, s56, s3
    s_addk_i32 s56, 0x37C
    s_lshl_b32 s56, s56, 14
    s_or_b32 s55, s55, s56
    s_lshl_b32 s56, s54, 10
    s_or_b32 s58, s55, s56
    v_lshrrev_b32 v1, 5, v0
    v_xor_b32 v4, v0, v1
    v_lshlrev_b32 v4, 4, v4
    s_lshl_b32 s34, 1, 28
    s_lshl_b32 s35, 1, 17
    s_movk_i32 s61, 0x400
    s_waitcnt lgkmcnt(0)
    s_mov_b64 s[32:33], s[6:7]
    buffer_load_dwordx4 v4, s[32:35], s58 offen nt lds
    s_add_u32 m0, m0, s61
    v_xor_b32 v5, 32, v4
    s_xor_b32 s62, s58, 1024
    buffer_load_dwordx4 v5, s[32:35], s62 offen nt lds
    s_add_u32 m0, m0, s61
    v_xor_b32 v6, 64, v4
    s_xor_b32 s62, s58, 2048
    buffer_load_dwordx4 v6, s[32:35], s62 offen nt lds
    s_add_u32 m0, m0, s61
    s_branch L_s1
.p2align 8
L_w23:
    s_setprio 3
    v_mov_b32 v3, 163232
    v_and_b32 v8, 7, v0
    s_cmp_lg_u32 s3, 2
    s_cbranch_scc1 L_nc
    v_mov_b32 v10, 0
    v_and_b32 v9, 15, v0
    v_lshl_add_u32 v9, v9, 2, v3
    ds_write_b32 v9, v10
    s_waitcnt lgkmcnt(0)
L_nc:
    s_barrier
    s_branch L_x23
L_s1:
    s_lshr_b32 s29, s2, 3
    s_mov_b32 s31, 0x100000
    s_mov_b32 s42, 1073741824
    s_mov_b32 s43, 0x20000
    s_mov_b32 s98, 2097152
    s_mov_b32 s99, 0x20000
    s_movk_i32 s79, 100
    s_lshl_b32 s54, s54, 1
    s_lshl_b32 s57, s53, 14
    s_mov_b64 s[36:37], s[8:9]
    s_mov_b64 s[38:39], s[34:35]
    s_and_b32 s56, s54, 28
    s_lshl_b32 s56, s56, 9
    s_or_b32 s59, s55, s56
    s_and_b32 s60, s53, 1
    s_lshl_b32 s56, s60, 8
    s_or_b32 s59, s59, s56
    s_mov_b64 s[40:41], s[26:27]
    s_mov_b64 s[96:97], s[26:27]
    s_load_dword s30, s[26:27], 0
    v_lshrrev_b32 v1, 4, v0
    v_and_b32 v8, 15, v0
    s_and_b32 s56, s54, 3
    v_xor_b32 v7, s56, v1
    v_lshlrev_b32 v7, 9, v7
    v_lshl_or_b32 v7, v8, 4, v7
    v_mov_b32 v3, 163232
    s_mov_b32 s63, 0
    s_barrier
    s_waitcnt vmcnt(2)
    v_xor_b32 v5, 96, v4
    s_xor_b32 s62, s58, 3072
    buffer_load_dwordx4 v5, s[32:35], s62 offen nt lds
    s_add_u32 m0, m0, s61
    s_waitcnt vmcnt(2)
    v_xor_b32 v6, 128, v4
    s_xor_b32 s62, s58, 4096
    buffer_load_dwordx4 v6, s[32:35], s62 offen nt lds
    s_add_u32 m0, m0, s61
    s_waitcnt vmcnt(2)
    v_xor_b32 v5, 160, v4
    s_xor_b32 s62, s58, 5120
    buffer_load_dwordx4 v5, s[32:35], s62 offen nt lds
    s_add_u32 m0, m0, s61
    s_waitcnt vmcnt(2)
    v_xor_b32 v6, 192, v4
    s_xor_b32 s62, s58, 6144
    buffer_load_dwordx4 v6, s[32:35], s62 offen nt lds
    s_add_u32 m0, m0, s61
    s_movk_i32 s65, 128
    s_lshr_b32 s52, s53, 2
    s_mulk_i32 s52, 20
    s_add_u32 s65, s65, s52
    s_cmpk_ge_u32 s65, 145
    s_cselect_b64 vcc, -1, 0
    s_waitcnt vmcnt(3)
    s_cbranch_vccnz L_lv1
    s_waitcnt vmcnt(2)
L_lv1:
    v_xor_b32 v5, 224, v4
    s_xor_b32 s62, s58, 7168
    buffer_load_dwordx4 v5, s[32:35], s62 offen nt lds
    s_add_u32 m0, m0, s61
    s_waitcnt vmcnt(3)
    s_cbranch_vccnz L_lv2
    s_waitcnt vmcnt(2)
L_lv2:
    s_xor_b32 s62, s58, 8192
    buffer_load_dwordx4 v4, s[32:35], s62 offen nt lds
    s_add_u32 m0, m0, s61
    s_waitcnt vmcnt(3)
    s_cbranch_vccnz L_lv3
    s_waitcnt vmcnt(2)
L_lv3:
    v_xor_b32 v5, 32, v4
    s_xor_b32 s62, s58, 9216
    buffer_load_dwordx4 v5, s[32:35], s62 offen nt lds
    s_add_u32 m0, m0, s61
    s_mov_b32 s77, 0
    ds_read_b32 v2, v3 offset:0
    s_waitcnt vmcnt(3)
    s_cbranch_vccnz L_lv4
    s_waitcnt vmcnt(2)
L_lv4:
    s_waitcnt lgkmcnt(0)
    v_readfirstlane_b32 s52, v2
    s_add_u32 s77, s77, s52
    v_xor_b32 v6, 64, v4
    s_xor_b32 s62, s58, 10240
    buffer_load_dwordx4 v6, s[32:35], s62 offen nt lds
    s_add_u32 m0, m0, s61
    ds_read_b32 v2, v3 offset:0
    s_waitcnt vmcnt(3)
    s_cbranch_vccnz L_lv5
    s_waitcnt vmcnt(2)
L_lv5:
    s_waitcnt lgkmcnt(0)
    v_readfirstlane_b32 s52, v2
    s_add_u32 s77, s77, s52
    v_xor_b32 v5, 96, v4
    s_xor_b32 s62, s58, 11264
    buffer_load_dwordx4 v5, s[32:35], s62 offen nt lds
    s_add_u32 m0, m0, s61
    ds_read_b32 v2, v3 offset:0
    s_waitcnt vmcnt(3)
    s_cbranch_vccnz L_lv6
    s_waitcnt vmcnt(2)
L_lv6:
    s_waitcnt lgkmcnt(0)
    v_readfirstlane_b32 s52, v2
    s_add_u32 s77, s77, s52
    v_xor_b32 v6, 128, v4
    s_xor_b32 s62, s58, 12288
    buffer_load_dwordx4 v6, s[32:35], s62 offen nt lds
    s_add_u32 m0, m0, s61
    ds_read_b32 v2, v3 offset:0
    s_waitcnt vmcnt(3)
    s_cbranch_vccnz L_lv7
    s_waitcnt vmcnt(2)
L_lv7:
    s_waitcnt lgkmcnt(0)
    v_readfirstlane_b32 s52, v2
    s_add_u32 s77, s77, s52
    v_xor_b32 v5, 160, v4
    s_xor_b32 s62, s58, 13312
    buffer_load_dwordx4 v5, s[32:35], s62 offen nt lds
    s_add_u32 m0, m0, s61
    ds_read_b32 v2, v3 offset:0
    s_waitcnt vmcnt(3)
    s_cbranch_vccnz L_lv8
    s_waitcnt vmcnt(2)
L_lv8:
    s_waitcnt lgkmcnt(0)
    v_readfirstlane_b32 s52, v2
    s_add_u32 s77, s77, s52
    v_xor_b32 v6, 192, v4
    s_xor_b32 s62, s58, 14336
    buffer_load_dwordx4 v6, s[32:35], s62 offen nt lds
    s_add_u32 m0, m0, s61
    ds_read_b32 v2, v3 offset:0
    s_waitcnt vmcnt(3)
    s_cbranch_vccnz L_lv9
    s_waitcnt vmcnt(2)
L_lv9:
    s_waitcnt lgkmcnt(0)
    v_readfirstlane_b32 s52, v2
    s_add_u32 s77, s77, s52
    v_xor_b32 v5, 224, v4
    s_xor_b32 s62, s58, 15360
    buffer_load_dwordx4 v5, s[32:35], s62 offen nt lds
    ds_read_b32 v2, v3 offset:0
    s_waitcnt vmcnt(3)
    s_cbranch_vccnz L_lv10
    s_waitcnt vmcnt(2)
L_lv10:
    s_waitcnt lgkmcnt(0)
    v_readfirstlane_b32 s52, v2
    s_add_u32 s77, s77, s52
    s_waitcnt lgkmcnt(0)
    s_add_u32 s30, s30, 2654435769
    s_and_b32 s72, s30, 0xff
    s_bfe_u32 s73, s30, 0x80008
    s_bfe_u32 s74, s30, 0x80010
    s_lshr_b32 s75, s30, 24
    buffer_load_dwordx4 v[16:19], v7, s[36:39], s59 offen nt
    s_waitcnt vmcnt(3)
    s_cbranch_vccnz L_lv11
    s_waitcnt vmcnt(2)
L_lv11:
    s_xor_b32 s62, s59, 2048
    buffer_load_dwordx4 v[20:23], v7, s[36:39], s62 offen nt
    s_waitcnt vmcnt(3)
    s_cbranch_vccnz L_lv12
    s_waitcnt vmcnt(2)
L_lv12:
    s_xor_b32 s62, s59, 4096
    buffer_load_dwordx4 v[24:27], v7, s[36:39], s62 offen nt
    ds_read_b32 v2, v3 offset:0
    s_waitcnt vmcnt(3)
    s_cbranch_vccnz L_lv13
    s_waitcnt vmcnt(2)
L_lv13:
    s_waitcnt lgkmcnt(0)
    v_readfirstlane_b32 s52, v2
    s_cmp_gt_u32 s52, s63
    s_movk_i32 s64, 1
    s_cbranch_scc1 L_qk
L_ret1:
    s_xor_b32 s62, s59, 6144
    buffer_load_dwordx4 v[28:31], v7, s[36:39], s62 offen nt
    s_waitcnt vmcnt(3)
    s_cbranch_vccnz L_lv14
    s_waitcnt vmcnt(2)
L_lv14:
    s_xor_b32 s62, s59, 8192
    buffer_load_dwordx4 v[32:35], v7, s[36:39], s62 offen nt
    s_waitcnt vmcnt(3)
    s_cbranch_vccnz L_lv15
    s_waitcnt vmcnt(2)
L_lv15:
    s_xor_b32 s62, s59, 10240
    buffer_load_dwordx4 v[36:39], v7, s[36:39], s62 offen nt
    ds_read_b32 v2, v3 offset:0
    s_waitcnt vmcnt(3)
    s_cbranch_vccnz L_lv16
    s_waitcnt vmcnt(2)
L_lv16:
    s_waitcnt lgkmcnt(0)
    v_readfirstlane_b32 s52, v2
    s_cmp_gt_u32 s52, s63
    s_movk_i32 s64, 2
    s_cbranch_scc1 L_qk
L_ret2:
    s_xor_b32 s62, s59, 12288
    buffer_load_dwordx4 v[40:43], v7, s[36:39], s62 offen nt
    s_waitcnt vmcnt(3)
    s_cbranch_vccnz L_lv17
    s_waitcnt vmcnt(2)
L_lv17:
    s_xor_b32 s62, s59, 14336
    buffer_load_dwordx4 v[44:47], v7, s[36:39], s62 offen nt
    s_waitcnt vmcnt(3)
    s_cbranch_vccnz L_lv18
    s_waitcnt vmcnt(2)
L_lv18:
    s_xor_b32 s62, s59, 256
    buffer_load_dwordx4 v[48:51], v7, s[36:39], s62 offen nt
    ds_read_b32 v2, v3 offset:0
    s_waitcnt vmcnt(3)
    s_cbranch_vccnz L_lv19
    s_waitcnt vmcnt(2)
L_lv19:
    s_waitcnt lgkmcnt(0)
    v_readfirstlane_b32 s52, v2
    s_cmp_gt_u32 s52, s63
    s_movk_i32 s64, 3
    s_cbranch_scc1 L_qk
L_ret3:
    s_xor_b32 s62, s59, 2304
    buffer_load_dwordx4 v[52:55], v7, s[36:39], s62 offen nt
    s_waitcnt vmcnt(3)
    s_cbranch_vccnz L_lv20
    s_waitcnt vmcnt(2)
L_lv20:
    s_xor_b32 s62, s59, 4352
    buffer_load_dwordx4 v[56:59], v7, s[36:39], s62 offen nt
    s_waitcnt vmcnt(3)
    s_cbranch_vccnz L_lv21
    s_waitcnt vmcnt(2)
L_lv21:
    s_xor_b32 s62, s59, 6400
    buffer_load_dwordx4 v[60:63], v7, s[36:39], s62 offen nt
    ds_read_b32 v2, v3 offset:0
    s_waitcnt vmcnt(3)
    s_cbranch_vccnz L_lv22
    s_waitcnt vmcnt(2)
L_lv22:
    s_waitcnt lgkmcnt(0)
    v_readfirstlane_b32 s52, v2
    s_cmp_gt_u32 s52, s63
    s_movk_i32 s64, 4
    s_cbranch_scc1 L_qk
L_ret4:
    s_xor_b32 s62, s59, 8448
    buffer_load_dwordx4 v[64:67], v7, s[36:39], s62 offen nt
    s_waitcnt vmcnt(3)
    s_cbranch_vccnz L_lv23
    s_waitcnt vmcnt(2)
L_lv23:
    s_xor_b32 s62, s59, 10496
    buffer_load_dwordx4 v[68:71], v7, s[36:39], s62 offen nt
    s_waitcnt vmcnt(3)
    s_cbranch_vccnz L_lv24
    s_waitcnt vmcnt(2)
L_lv24:
    s_xor_b32 s62, s59, 12544
    buffer_load_dwordx4 v[72:75], v7, s[36:39], s62 offen nt
    s_waitcnt vmcnt(3)
    s_cbranch_vccnz L_lv25
    s_waitcnt vmcnt(2)
L_lv25:
    s_xor_b32 s62, s59, 14592
    buffer_load_dwordx4 v[76:79], v7, s[36:39], s62 offen nt
    s_mov_b64 exec, 1
    v_mov_b32 v2, 1
    ds_add_u32 v3, v2 offset:20
    s_mov_b64 exec, -1
    s_cmp_lg_u32 s63, 0
    s_cbranch_scc1 L_pv
L_sp26:
    ds_read_b32 v2, v3 offset:0
    s_waitcnt lgkmcnt(0)
    v_readfirstlane_b32 s52, v2
    s_cmp_eq_u32 s52, 1
    s_cbranch_scc1 L_sd27
    s_sleep 1
    s_sub_u32 s31, s31, 1
    s_cbranch_scc0 L_sp26
    s_mov_b32 s31, 0
L_sd27:
    s_waitcnt vmcnt(16)
    s_mov_b32 s64, 0
L_qk:
    s_mov_b32 s63, 1
    v_lshrrev_b32 v1, 4, v0
    v_and_b32 v9, 1, v8
    v_mul_u32_u24 v9, 576, v9
    v_lshl_add_u32 v9, v1, 4, v9
    v_add_u32 v9, 159744, v9
    ds_read_b128 v[80:83], v9 offset:0
    ds_read_b128 v[84:87], v9 offset:64
    ds_read_b128 v[88:91], v9 offset:128
    ds_read_b128 v[92:95], v9 offset:192
    ds_read_b128 v[96:99], v9 offset:256
    ds_read_b128 v[100:103], v9 offset:320
    ds_read_b128 v[104:107], v9 offset:384
    ds_read_b128 v[108:111], v9 offset:448
    v_and_b32 v10, 3, v8
    v_lshrrev_b32 v11, 2, v8
    v_lshl_or_b32 v10, v10, 2, v11
    v_xor_b32 v11, v10, v1
    v_lshlrev_b32 v11, 4, v11
    v_lshl_or_b32 v10, v10, 9, v11
    v_add_u32 v10, s57, v10
    v_xor_b32 v11, 64, v10
    v_xor_b32 v12, 0x80, v10
    v_xor_b32 v13, 0xc0, v10
    ds_read_b128 v[112:115], v10 offset:0
    ds_read_b128 v[116:119], v10 offset:8192
    ds_read_b128 v[120:123], v11 offset:0
    ds_read_b128 v[124:127], v11 offset:8192
    ds_read_b128 v[128:131], v12 offset:0
    ds_read_b128 v[132:135], v12 offset:8192
    ds_read_b128 v[136:139], v13 offset:0
    ds_read_b128 v[140:143], v13 offset:8192
    s_waitcnt lgkmcnt(0)
    v_mfma_f32_16x16x32_bf16 v[144:147], v[112:115], v[80:83], 0
    v_mfma_f32_16x16x32_bf16 v[148:151], v[116:119], v[80:83], 0
    v_mfma_f32_16x16x32_bf16 v[144:147], v[120:123], v[84:87], v[144:147]
    v_mfma_f32_16x16x32_bf16 v[148:151], v[124:127], v[84:87], v[148:151]
    v_mfma_f32_16x16x32_bf16 v[144:147], v[128:131], v[88:91], v[144:147]
    v_mfma_f32_16x16x32_bf16 v[148:151], v[132:135], v[88:91], v[148:151]
    v_mfma_f32_16x16x32_bf16 v[144:147], v[136:139], v[92:95], v[144:147]
    v_mfma_f32_16x16x32_bf16 v[148:151], v[140:143], v[92:95], v[148:151]
    ds_read_b128 v[112:115], v10 offset:256
    ds_read_b128 v[116:119], v10 offset:8448
    ds_read_b128 v[120:123], v11 offset:256
    ds_read_b128 v[124:127], v11 offset:8448
    ds_read_b128 v[128:131], v12 offset:256
    ds_read_b128 v[132:135], v12 offset:8448
    ds_read_b128 v[136:139], v13 offset:256
    ds_read_b128 v[140:143], v13 offset:8448
    s_waitcnt lgkmcnt(0)
    v_mfma_f32_16x16x32_bf16 v[144:147], v[112:115], v[96:99], v[144:147]
    v_mfma_f32_16x16x32_bf16 v[148:151], v[116:119], v[96:99], v[148:151]
    v_mfma_f32_16x16x32_bf16 v[144:147], v[120:123], v[100:103], v[144:147]
    v_mfma_f32_16x16x32_bf16 v[148:151], v[124:127], v[100:103], v[148:151]
    v_mfma_f32_16x16x32_bf16 v[144:147], v[128:131], v[104:107], v[144:147]
    v_mfma_f32_16x16x32_bf16 v[148:151], v[132:135], v[104:107], v[148:151]
    v_mfma_f32_16x16x32_bf16 v[144:147], v[136:139], v[108:111], v[144:147]
    v_mfma_f32_16x16x32_bf16 v[148:151], v[140:143], v[108:111], v[148:151]
    s_nop 6
    v_cvt_pk_bf16_f32 v112, v144, v145
    v_cvt_pk_bf16_f32 v113, v146, v147
    v_cvt_pk_bf16_f32 v114, v148, v149
    v_cvt_pk_bf16_f32 v115, v150, v151
    v_lshlrev_b32 v144, 16, v112
    v_and_b32 v145, 0xffff0000, v112
    v_lshlrev_b32 v146, 16, v113
    v_and_b32 v147, 0xffff0000, v113
    v_lshlrev_b32 v148, 16, v114
    v_and_b32 v149, 0xffff0000, v114
    v_lshlrev_b32 v150, 16, v115
    v_and_b32 v151, 0xffff0000, v115
    v_max3_f32 v10, v144, v145, v146
    v_max3_f32 v11, v147, v148, v149
    v_max3_f32 v10, v10, v150, v151
    v_max_f32 v10, v10, v11
    v_mov_b32 v11, v10
    s_nop 1
    v_permlane32_swap_b32 v10, v11
    v_max_f32 v10, v10, v11
    v_mov_b32 v11, v10
    s_nop 1
    v_permlane16_swap_b32 v10, v11
    v_max_f32 v10, v10, v11
    s_mov_b32 s52, 1035512379
    v_sub_f32 v144, v144, v10
    v_sub_f32 v145, v145, v10
    v_sub_f32 v146, v146, v10
    v_sub_f32 v147, v147, v10
    v_sub_f32 v148, v148, v10
    v_sub_f32 v149, v149, v10
    v_sub_f32 v150, v150, v10
    v_sub_f32 v151, v151, v10
    v_mul_f32 v144, s52, v144
    v_mul_f32 v145, s52, v145
    v_mul_f32 v146, s52, v146
    v_mul_f32 v147, s52, v147
    v_mul_f32 v148, s52, v148
    v_mul_f32 v149, s52, v149
    v_mul_f32 v150, s52, v150
    v_mul_f32 v151, s52, v151
    v_exp_f32 v144, v144
    v_exp_f32 v145, v145
    v_exp_f32 v146, v146
    v_exp_f32 v147, v147
    v_exp_f32 v148, v148
    v_exp_f32 v149, v149
    v_exp_f32 v150, v150
    v_exp_f32 v151, v151
    v_cvt_pk_bf16_f32 v112, v144, v145
    v_cvt_pk_bf16_f32 v113, v146, v147
    v_cvt_pk_bf16_f32 v114, v148, v149
    v_cvt_pk_bf16_f32 v115, v150, v151
    v_add_f32 v144, v144, v148
    v_add_f32 v145, v145, v149
    v_add_f32 v146, v146, v150
    v_add_f32 v147, v147, v151
    v_add_f32 v144, v144, v145
    v_add_f32 v146, v146, v147
    v_add_f32 v11, v144, v146
    v_mov_b32 v12, v11
    s_nop 1
    v_permlane32_swap_b32 v11, v12
    v_add_f32 v11, v11, v12
    v_mov_b32 v12, v11
    s_nop 1
    v_permlane16_swap_b32 v11, v12
    v_add_f32 v11, v11, v12
    s_lshl_b32 s52, s53, 4
    s_add_u32 s52, s52, 163008
    v_lshl_add_u32 v12, v0, 3, s52
    s_mov_b64 exec, 3
    ds_write_b64 v12, v[10:11]
    s_mov_b64 exec, 1
    v_mov_b32 v2, 1
    ds_add_u32 v3, v2 offset:12
    s_mov_b64 exec, -1
    s_mov_b32 s66, 196611
    s_mov_b32 s67, s66
    v_cndmask_b32 v80, 0, v112, s[66:67]
    v_cndmask_b32 v81, 0, v113, s[66:67]
    v_cndmask_b32 v82, 0, v114, s[66:67]
    v_cndmask_b32 v83, 0, v115, s[66:67]
    s_mov_b32 s66, 786444
    s_mov_b32 s67, s66
    v_cndmask_b32 v84, 0, v112, s[66:67]
    v_cndmask_b32 v85, 0, v113, s[66:67]
    v_cndmask_b32 v86, 0, v114, s[66:67]
    v_cndmask_b32 v87, 0, v115, s[66:67]
    s_mov_b32 s66, 3145776
    s_mov_b32 s67, s66
    v_cndmask_b32 v88, 0, v112, s[66:67]
    v_cndmask_b32 v89, 0, v113, s[66:67]
    v_cndmask_b32 v90, 0, v114, s[66:67]
    v_cndmask_b32 v91, 0, v115, s[66:67]
    s_mov_b32 s66, 12583104
    s_mov_b32 s67, s66
    v_cndmask_b32 v92, 0, v112, s[66:67]
    v_cndmask_b32 v93, 0, v113, s[66:67]
    v_cndmask_b32 v94, 0, v114, s[66:67]
    v_cndmask_b32 v95, 0, v115, s[66:67]
    s_mov_b32 s66, 50332416
    s_mov_b32 s67, s66
    v_cndmask_b32 v96, 0, v112, s[66:67]
    v_cndmask_b32 v97, 0, v113, s[66:67]
    v_cndmask_b32 v98, 0, v114, s[66:67]
    v_cndmask_b32 v99, 0, v115, s[66:67]
    s_mov_b32 s66, 201329664
    s_mov_b32 s67, s66
    v_cndmask_b32 v100, 0, v112, s[66:67]
    v_cndmask_b32 v101, 0, v113, s[66:67]
    v_cndmask_b32 v102, 0, v114, s[66:67]
    v_cndmask_b32 v103, 0, v115, s[66:67]
    s_mov_b32 s66, 805318656
    s_mov_b32 s67, s66
    v_cndmask_b32 v104, 0, v112, s[66:67]
    v_cndmask_b32 v105, 0, v113, s[66:67]
    v_cndmask_b32 v106, 0, v114, s[66:67]
    v_cndmask_b32 v107, 0, v115, s[66:67]
    s_mov_b32 s66, 3221274624
    s_mov_b32 s67, s66
    v_cndmask_b32 v108, 0, v112, s[66:67]
    v_cndmask_b32 v109, 0, v113, s[66:67]
    v_cndmask_b32 v110, 0, v114, s[66:67]
    v_cndmask_b32 v111, 0, v115, s[66:67]
    s_movk_i32 s65, 128
    s_mul_i32 s52, s77, 10
    s_add_u32 s65, s65, s52
    s_lshr_b32 s52, s53, 2
    s_mulk_i32 s52, 10
    s_add_u32 s65, s65, s52
    s_cmpk_ge_u32 s65, 145
    s_cselect_b64 vcc, -1, 0
    s_cmp_eq_u32 s64, 1
    s_cbranch_scc1 L_fre1
    s_cmp_eq_u32 s64, 2
    s_cbranch_scc1 L_fre2
    s_cmp_eq_u32 s64, 3
    s_cbranch_scc1 L_fre3
    s_cmp_eq_u32 s64, 4
    s_cbranch_scc1 L_fre4
    s_branch L_pv
L_fre1:
    s_xor_b32 s62, s59, 6144
    buffer_load_dwordx4 v[28:31], v7, s[36:39], s62 offen nt
    s_waitcnt vmcnt(6)
    s_cbranch_vccnz L_lv28
    s_waitcnt vmcnt(4)
    s_cmpk_ge_u32 s65, 135
    s_cbranch_scc1 L_lv28
    s_waitcnt vmcnt(3)
L_lv28:
    s_xor_b32 s62, s59, 8192
    buffer_load_dwordx4 v[32:35], v7, s[36:39], s62 offen nt
    s_waitcnt vmcnt(6)
    s_cbranch_vccnz L_lv29
    s_waitcnt vmcnt(4)
    s_cmpk_ge_u32 s65, 135
    s_cbranch_scc1 L_lv29
    s_waitcnt vmcnt(3)
L_lv29:
    s_xor_b32 s62, s59, 10240
    buffer_load_dwordx4 v[36:39], v7, s[36:39], s62 offen nt
    s_waitcnt vmcnt(6)
    s_cbranch_vccnz L_lv30
    s_waitcnt vmcnt(4)
    s_cmpk_ge_u32 s65, 135
    s_cbranch_scc1 L_lv30
    s_waitcnt vmcnt(3)
L_lv30:
L_fre2:
    s_xor_b32 s62, s59, 12288
    buffer_load_dwordx4 v[40:43], v7, s[36:39], s62 offen nt
    s_waitcnt vmcnt(6)
    s_cbranch_vccnz L_lv31
    s_waitcnt vmcnt(4)
    s_cmpk_ge_u32 s65, 135
    s_cbranch_scc1 L_lv31
    s_waitcnt vmcnt(3)
L_lv31:
    s_xor_b32 s62, s59, 14336
    buffer_load_dwordx4 v[44:47], v7, s[36:39], s62 offen nt
    s_waitcnt vmcnt(6)
    s_cbranch_vccnz L_lv32
    s_waitcnt vmcnt(4)
    s_cmpk_ge_u32 s65, 135
    s_cbranch_scc1 L_lv32
    s_waitcnt vmcnt(3)
L_lv32:
    s_xor_b32 s62, s59, 256
    buffer_load_dwordx4 v[48:51], v7, s[36:39], s62 offen nt
    s_waitcnt vmcnt(6)
    s_cbranch_vccnz L_lv33
    s_waitcnt vmcnt(4)
    s_cmpk_ge_u32 s65, 135
    s_cbranch_scc1 L_lv33
    s_waitcnt vmcnt(3)
L_lv33:
L_fre3:
    s_xor_b32 s62, s59, 2304
    buffer_load_dwordx4 v[52:55], v7, s[36:39], s62 offen nt
    s_waitcnt vmcnt(6)
    s_cbranch_vccnz L_lv34
    s_waitcnt vmcnt(4)
    s_cmpk_ge_u32 s65, 135
    s_cbranch_scc1 L_lv34
    s_waitcnt vmcnt(3)
L_lv34:
    s_xor_b32 s62, s59, 4352
    buffer_load_dwordx4 v[56:59], v7, s[36:39], s62 offen nt
    s_waitcnt vmcnt(6)
    s_cbranch_vccnz L_lv35
    s_waitcnt vmcnt(4)
    s_cmpk_ge_u32 s65, 135
    s_cbranch_scc1 L_lv35
    s_waitcnt vmcnt(3)
L_lv35:
    s_xor_b32 s62, s59, 6400
    buffer_load_dwordx4 v[60:63], v7, s[36:39], s62 offen nt
    s_waitcnt vmcnt(6)
    s_cbranch_vccnz L_lv36
    s_waitcnt vmcnt(4)
    s_cmpk_ge_u32 s65, 135
    s_cbranch_scc1 L_lv36
    s_waitcnt vmcnt(3)
L_lv36:
L_fre4:
    s_xor_b32 s62, s59, 8448
    buffer_load_dwordx4 v[64:67], v7, s[36:39], s62 offen nt
    s_waitcnt vmcnt(6)
    s_cbranch_vccnz L_lv37
    s_waitcnt vmcnt(4)
    s_cmpk_ge_u32 s65, 135
    s_cbranch_scc1 L_lv37
    s_waitcnt vmcnt(3)
L_lv37:
    s_xor_b32 s62, s59, 10496
    buffer_load_dwordx4 v[68:71], v7, s[36:39], s62 offen nt
    s_waitcnt vmcnt(6)
    s_cbranch_vccnz L_lv38
    s_waitcnt vmcnt(4)
    s_cmpk_ge_u32 s65, 135
    s_cbranch_scc1 L_lv38
    s_waitcnt vmcnt(3)
L_lv38:
    s_xor_b32 s62, s59, 12544
    buffer_load_dwordx4 v[72:75], v7, s[36:39], s62 offen nt
    s_waitcnt vmcnt(6)
    s_cbranch_vccnz L_lv39
    s_waitcnt vmcnt(4)
    s_cmpk_ge_u32 s65, 135
    s_cbranch_scc1 L_lv39
    s_waitcnt vmcnt(3)
L_lv39:
    s_xor_b32 s62, s59, 14592
    buffer_load_dwordx4 v[76:79], v7, s[36:39], s62 offen nt
    s_mov_b64 exec, 1
    v_mov_b32 v2, 1
    ds_add_u32 v3, v2 offset:20
    s_mov_b64 exec, -1
L_pv:
    s_mov_b32 s64, 0x05040100
    s_mov_b32 s65, 0x07060302
    s_lshl_b32 s52, s60, 10
    s_add_u32 s66, s52, s57
    s_xor_b32 s67, s66, 0x400
    v_lshl_add_u32 v10, v0, 4, s66
    v_lshl_add_u32 v11, v0, 4, s67
    s_mov_b32 s46, 1792
    s_mov_b32 s47, 0x20000
    s_mov_b32 s50, 1792
    s_mov_b32 s51, 0x20000
    s_mov_b64 s[44:45], s[4:5]
    s_mov_b64 s[48:49], s[22:23]
    s_lshr_b32 s52, s29, 2
    s_lshl_b32 s52, s52, 3
    s_add_u32 s69, s52, s28
    s_lshl_b32 s52, s69, 2
    s_and_b32 s54, s29, 3
    s_add_u32 s52, s52, s54
    s_mul_i32 s70, s52, 32
    s_add_u32 s70, s70, 983040
    s_mul_i32 s71, s52, 16
    s_sub_u32 s52, s53, 4
    s_mul_i32 s52, s52, 237568
    s_add_u32 s70, s70, s52
    v_lshrrev_b32 v14, 1, v0
    s_movk_i32 s52, 3712
    v_mul_u32_u24 v14, s52, v14
    v_and_b32 v15, 1, v0
    v_lshl_add_u32 v14, v15, 4, v14
    v_lshrrev_b32 v13, 5, v0
    v_bfe_u32 v12, v0, 4, 1
    v_lshl_or_b32 v13, v12, 1, v13
    v_lshlrev_b32 v13, 1, v13
    v_lshl_add_u32 v15, v15, 3, v13
    v_add_u32 v15, s71, v15
    buffer_load_ushort v9, v15, s[44:47], 0 offen
    s_lshl_b32 s52, s60, 10
    v_lshl_add_u32 v12, v0, 4, s52
    v_and_b32 v13, 1, v0
    v_mov_b32 v8, 163136
    v_lshl_add_u32 v13, v13, 5, v8
    s_mul_i32 s52, s28, 69632
    s_mul_i32 s54, s29, 2176
    s_add_u32 s52, s52, s54
    s_mul_i32 s54, s60, 1024
    s_add_u32 s52, s52, s54
    s_add_u32 s68, s52, 409600
    v_lshrrev_b32 v7, 2, v0
    s_movk_i32 s52, 64
    v_mul_u32_u24 v7, s52, v7
    v_and_b32 v8, 3, v0
    v_lshl_add_u32 v2, v8, 4, v7
    v_mov_b32 v8, 0xffffff00
    v_lshrrev_b32 v1, 2, v0
    s_movk_i32 s52, 2176
    v_mul_u32_u24 v1, s52, v1
    v_and_b32 v6, 3, v0
    v_lshl_add_u32 v1, v6, 4, v1
    s_mul_i32 s52, s28, 69632
    s_mul_i32 s54, s29, 64
    s_add_u32 s52, s52, s54
    s_add_u32 s76, s52, 409600
    s_add_u32 s77, s76, 34816
    v_lshrrev_b32 v5, 4, v0
    v_lshl_or_b32 v5, v5, 2, v6
    v_mov_b32 v6, 162944
    v_lshl_add_u32 v3, v5, 2, v6
    s_lshl_b32 s54, s28, 10
    s_add_u32 s54, s54, 4096
    v_lshrrev_b32 v5, 2, v0
    v_and_b32 v6, 1, v0
    v_lshlrev_b32 v5, 5, v5
    v_lshl_or_b32 v5, v6, 4, v5
    s_mov_b32 s56, 1035512379
    s_waitcnt vmcnt(9)
    buffer_load_dwordx4 v[144:147], v5, s[96:99], s54 offen sc1
    buffer_load_dwordx4 v[148:151], v5, s[96:99], s54 offen offset:512 sc1
    v_perm_b32 v112, v20, v16, s64
    v_perm_b32 v116, v20, v16, s65
    v_perm_b32 v120, v21, v17, s64
    v_perm_b32 v124, v21, v17, s65
    v_perm_b32 v128, v22, v18, s64
    v_perm_b32 v132, v22, v18, s65
    v_perm_b32 v136, v23, v19, s64
    v_perm_b32 v140, v23, v19, s65
    v_perm_b32 v113, v28, v24, s64
    v_perm_b32 v117, v28, v24, s65
    v_perm_b32 v121, v29, v25, s64
    v_perm_b32 v125, v29, v25, s65
    v_perm_b32 v129, v30, v26, s64
    v_perm_b32 v133, v30, v26, s65
    v_perm_b32 v137, v31, v27, s64
    v_perm_b32 v141, v31, v27, s65
    v_perm_b32 v114, v36, v32, s64
    v_perm_b32 v118, v36, v32, s65
    v_perm_b32 v122, v37, v33, s64
    v_perm_b32 v126, v37, v33, s65
    v_perm_b32 v130, v38, v34, s64
    v_perm_b32 v134, v38, v34, s65
    v_perm_b32 v138, v39, v35, s64
    v_perm_b32 v142, v39, v35, s65
    v_perm_b32 v115, v44, v40, s64
    v_perm_b32 v119, v44, v40, s65
    v_perm_b32 v123, v45, v41, s64
    v_perm_b32 v127, v45, v41, s65
    v_perm_b32 v131, v46, v42, s64
    v_perm_b32 v135, v46, v42, s65
    v_perm_b32 v139, v47, v43, s64
    v_perm_b32 v143, v47, v43, s65
    v_mfma_f32_16x16x32_bf16 v[152:155], v[112:115], v[80:83], 0
    v_mfma_f32_16x16x32_bf16 v[152:155], v[116:119], v[84:87], v[152:155]
    v_mfma_f32_16x16x32_bf16 v[152:155], v[120:123], v[88:91], v[152:155]
    v_mfma_f32_16x16x32_bf16 v[152:155], v[124:127], v[92:95], v[152:155]
    v_mfma_f32_16x16x32_bf16 v[152:155], v[128:131], v[96:99], v[152:155]
    v_mfma_f32_16x16x32_bf16 v[152:155], v[132:135], v[100:103], v[152:155]
    v_mfma_f32_16x16x32_bf16 v[152:155], v[136:139], v[104:107], v[152:155]
    v_mfma_f32_16x16x32_bf16 v[152:155], v[140:143], v[108:111], v[152:155]
    s_waitcnt vmcnt(9)
    v_perm_b32 v112, v52, v48, s64
    v_perm_b32 v116, v52, v48, s65
    v_perm_b32 v120, v53, v49, s64
    v_perm_b32 v124, v53, v49, s65
    v_perm_b32 v128, v54, v50, s64
    v_perm_b32 v132, v54, v50, s65
    v_perm_b32 v136, v55, v51, s64
    v_perm_b32 v140, v55, v51, s65
    ds_write_b128 v10, v[152:155]
    s_waitcnt vmcnt(7)
    v_perm_b32 v113, v60, v56, s64
    v_perm_b32 v117, v60, v56, s65
    v_perm_b32 v121, v61, v57, s64
    v_perm_b32 v125, v61, v57, s65
    v_perm_b32 v129, v62, v58, s64
    v_perm_b32 v133, v62, v58, s65
    v_perm_b32 v137, v63, v59, s64
    v_perm_b32 v141, v63, v59, s65
    s_waitcnt vmcnt(5)
    v_perm_b32 v114, v68, v64, s64
    v_perm_b32 v118, v68, v64, s65
    v_perm_b32 v122, v69, v65, s64
    v_perm_b32 v126, v69, v65, s65
    v_perm_b32 v130, v70, v66, s64
    v_perm_b32 v134, v70, v66, s65
    v_perm_b32 v138, v71, v67, s64
    v_perm_b32 v142, v71, v67, s65
    s_waitcnt vmcnt(3)
    v_perm_b32 v115, v76, v72, s64
    v_perm_b32 v119, v76, v72, s65
    v_perm_b32 v123, v77, v73, s64
    v_mfma_f32_16x16x32_bf16 v[156:159], v[112:115], v[80:83], 0
    v_perm_b32 v127, v77, v73, s65
    v_mfma_f32_16x16x32_bf16 v[156:159], v[116:119], v[84:87], v[156:159]
    v_perm_b32 v131, v78, v74, s64
    v_mfma_f32_16x16x32_bf16 v[156:159], v[120:123], v[88:91], v[156:159]
    v_perm_b32 v135, v78, v74, s65
    v_mfma_f32_16x16x32_bf16 v[156:159], v[124:127], v[92:95], v[156:159]
    v_perm_b32 v139, v79, v75, s64
    v_mfma_f32_16x16x32_bf16 v[156:159], v[128:131], v[96:99], v[156:159]
    v_perm_b32 v143, v79, v75, s65
    v_mfma_f32_16x16x32_bf16 v[156:159], v[132:135], v[100:103], v[156:159]
    v_mfma_f32_16x16x32_bf16 v[156:159], v[136:139], v[104:107], v[156:159]
    v_mfma_f32_16x16x32_bf16 v[156:159], v[140:143], v[108:111], v[156:159]
    s_nop 7
    ds_write_b128 v11, v[156:159]
    s_waitcnt lgkmcnt(0)
    s_barrier
    s_setprio 3
    s_cmp_ge_u32 s53, 2
    s_cbranch_scc1 L_red
    ds_read_b128 v[48:51], v13
    ds_read_b128 v[16:19], v12
    ds_read_b128 v[20:23], v12 offset:16384
    ds_read_b128 v[24:27], v12 offset:32768
    ds_read_b128 v[28:31], v12 offset:49152
    ds_read_b128 v[52:55], v13 offset:16
    v_add_u32 v12, 0x10000, v12
    ds_read_b128 v[32:35], v12 offset:0
    ds_read_b128 v[36:39], v12 offset:16384
    ds_read_b128 v[40:43], v12 offset:32768
    ds_read_b128 v[44:47], v12 offset:49152
    s_waitcnt lgkmcnt(8)
    v_pk_mul_f32 v[4:5], v[16:17], v[48:49] op_sel_hi:[1,0]
    v_pk_mul_f32 v[6:7], v[18:19], v[48:49] op_sel_hi:[1,0]
    s_waitcnt lgkmcnt(7)
    v_pk_fma_f32 v[4:5], v[20:21], v[48:49], v[4:5] op_sel:[0,1,0] op_sel_hi:[1,1,1]
    v_pk_fma_f32 v[6:7], v[22:23], v[48:49], v[6:7] op_sel:[0,1,0] op_sel_hi:[1,1,1]
    s_waitcnt lgkmcnt(6)
    v_pk_fma_f32 v[4:5], v[24:25], v[50:51], v[4:5] op_sel_hi:[1,0,1]
    v_pk_fma_f32 v[6:7], v[26:27], v[50:51], v[6:7] op_sel_hi:[1,0,1]
    s_waitcnt lgkmcnt(5)
    v_pk_fma_f32 v[4:5], v[28:29], v[50:51], v[4:5] op_sel:[0,1,0] op_sel_hi:[1,1,1]
    v_pk_fma_f32 v[6:7], v[30:31], v[50:51], v[6:7] op_sel:[0,1,0] op_sel_hi:[1,1,1]
    s_waitcnt lgkmcnt(3)
    v_pk_fma_f32 v[4:5], v[32:33], v[52:53], v[4:5] op_sel_hi:[1,0,1]
    v_pk_fma_f32 v[6:7], v[34:35], v[52:53], v[6:7] op_sel_hi:[1,0,1]
    s_waitcnt lgkmcnt(2)
    v_pk_fma_f32 v[4:5], v[36:37], v[52:53], v[4:5] op_sel:[0,1,0] op_sel_hi:[1,1,1]
    v_pk_fma_f32 v[6:7], v[38:39], v[52:53], v[6:7] op_sel:[0,1,0] op_sel_hi:[1,1,1]
    s_waitcnt lgkmcnt(1)
    v_pk_fma_f32 v[4:5], v[40:41], v[54:55], v[4:5] op_sel_hi:[1,0,1]
    v_pk_fma_f32 v[6:7], v[42:43], v[54:55], v[6:7] op_sel_hi:[1,0,1]
    s_waitcnt lgkmcnt(0)
    v_pk_fma_f32 v[4:5], v[44:45], v[54:55], v[4:5] op_sel:[0,1,0] op_sel_hi:[1,1,1]
    v_pk_fma_f32 v[6:7], v[46:47], v[54:55], v[6:7] op_sel:[0,1,0] op_sel_hi:[1,1,1]
    v_and_or_b32 v4, v4, v8, s72
    v_and_or_b32 v5, v5, v8, s73
    v_and_or_b32 v6, v6, v8, s74
    v_and_or_b32 v7, v7, v8, s75
    buffer_store_dwordx4 v[4:7], v2, s[40:43], s68 offen
    s_barrier
    s_branch L_fin
L_red:
    s_cmp_ge_u32 s53, 4
    s_cbranch_scc1 L_red2
    s_cmp_lg_u32 s53, 3
    s_cbranch_scc1 L_fin
    s_branch L_se42
L_sp40:
    buffer_load_dwordx4 v[144:147], v5, s[96:99], s54 offen sc1
    buffer_load_dwordx4 v[148:151], v5, s[96:99], s54 offen offset:512 sc1
L_se42:
    s_waitcnt vmcnt(0)
    v_xor_b32 v12, s30, v145
    v_bitop3_b32 v12, v12, v147, s30 bitop3:0xf6
    v_bitop3_b32 v12, v12, v149, s30 bitop3:0xf6
    v_bitop3_b32 v12, v12, v151, s30 bitop3:0xf6
    v_cmp_ne_u32 vcc, 0, v12
    s_cbranch_vccz L_sd41
    s_sub_u32 s79, s79, 1
    s_cbranch_scc1 L_mi44
L_sc43:
    s_sleep 1
    s_sub_u32 s31, s31, 64
    s_cbranch_scc0 L_sp40
    s_mov_b32 s31, 0
L_sd41:
    v_mov_b32 v12, v144
    v_mov_b32 v13, v148
    v_mov_b32 v6, v144
    v_mov_b32 v7, v148
    s_nop 0
    v_permlane32_swap_b32 v12, v6
    v_permlane32_swap_b32 v13, v7
    v_max_f32 v12, v12, v6
    v_max_f32 v13, v13, v7
    v_mov_b32 v6, v12
    v_mov_b32 v7, v13
    s_nop 0
    v_permlane16_swap_b32 v12, v6
    v_permlane16_swap_b32 v13, v7
    v_max_f32 v12, v12, v6
    v_max_f32 v13, v13, v7
    s_nop 0
    v_max_f32_dpp v12, v12, v12 row_ror:8 row_mask:0xf bank_mask:0xf
    v_max_f32_dpp v13, v13, v13 row_ror:8 row_mask:0xf bank_mask:0xf
    s_nop 0
    v_max_f32_dpp v12, v12, v12 row_ror:4 row_mask:0xf bank_mask:0xf
    v_max_f32_dpp v13, v13, v13 row_ror:4 row_mask:0xf bank_mask:0xf
    v_sub_f32 v10, v144, v12
    v_sub_f32 v11, v148, v13
    v_mul_f32 v10, s56, v10
    v_mul_f32 v11, s56, v11
    v_exp_f32 v10, v10
    v_exp_f32 v11, v11
    v_mul_f32 v4, v10, v146
    v_mul_f32 v5, v11, v150
    v_mov_b32 v12, v4
    v_mov_b32 v13, v5
    v_mov_b32 v6, v4
    v_mov_b32 v7, v5
    s_nop 0
    v_permlane32_swap_b32 v12, v6
    v_permlane32_swap_b32 v13, v7
    v_add_f32 v12, v12, v6
    v_add_f32 v13, v13, v7
    v_mov_b32 v6, v12
    v_mov_b32 v7, v13
    s_nop 0
    v_permlane16_swap_b32 v12, v6
    v_permlane16_swap_b32 v13, v7
    v_add_f32 v12, v12, v6
    v_add_f32 v13, v13, v7
    s_nop 0
    v_add_f32_dpp v12, v12, v12 row_ror:8 row_mask:0xf bank_mask:0xf
    v_add_f32_dpp v13, v13, v13 row_ror:8 row_mask:0xf bank_mask:0xf
    s_nop 0
    v_add_f32_dpp v12, v12, v12 row_ror:4 row_mask:0xf bank_mask:0xf
    v_add_f32_dpp v13, v13, v13 row_ror:4 row_mask:0xf bank_mask:0xf
    v_rcp_f32 v12, v12
    v_rcp_f32 v13, v13
    v_mul_f32 v10, v10, v12
    v_mul_f32 v11, v11, v13
L_sp45:
    buffer_load_dwordx4 v[16:19], v1, s[96:99], s76 offen sc1
    buffer_load_dwordx4 v[20:23], v1, s[96:99], s77 offen sc1
    s_waitcnt vmcnt(0)
    v_xor_b32 v16, s72, v16
    v_xor_b32 v17, s73, v17
    v_xor_b32 v18, s74, v18
    v_xor_b32 v19, s75, v19
    v_xor_b32 v20, s72, v20
    v_xor_b32 v21, s73, v21
    v_xor_b32 v22, s74, v22
    v_xor_b32 v23, s75, v23
    v_or3_b32 v12, v16, v17, v18
    v_or3_b32 v13, v19, v20, v21
    v_or3_b32 v12, v12, v22, v23
    v_pk_mul_f32 v[16:17], v[16:17], v[10:11] op_sel_hi:[1,0]
    v_pk_mul_f32 v[18:19], v[18:19], v[10:11] op_sel_hi:[1,0]
    v_pk_mul_f32 v[20:21], v[20:21], v[10:11] op_sel:[0,1] op_sel_hi:[1,1]
    v_pk_mul_f32 v[22:23], v[22:23], v[10:11] op_sel:[0,1] op_sel_hi:[1,1]
    s_nop 0
    v_permlane32_swap_b32 v16, v20
    v_permlane32_swap_b32 v17, v21
    v_permlane32_swap_b32 v18, v22
    v_permlane32_swap_b32 v19, v23
    v_or_b32 v12, v12, v13
    v_add_f32 v4, v16, v20
    v_add_f32 v5, v17, v21
    v_add_f32 v6, v18, v22
    v_add_f32 v7, v19, v23
    v_and_b32 v12, 0xff, v12
    v_permlane16_swap_b32 v4, v6
    v_permlane16_swap_b32 v5, v7
    v_cmp_ne_u32 vcc, 0, v12
    v_add_f32 v4, v4, v6
    v_add_f32 v5, v5, v7
    s_nop 0
    v_add_f32_dpp v4, v4, v4 row_ror:8 row_mask:0xf bank_mask:0xf
    v_add_f32_dpp v5, v5, v5 row_ror:8 row_mask:0xf bank_mask:0xf
    s_nop 0
    v_add_f32_dpp v4, v4, v4 row_ror:4 row_mask:0xf bank_mask:0xf
    v_add_f32_dpp v5, v5, v5 row_ror:4 row_mask:0xf bank_mask:0xf
    v_cvt_pk_bf16_f32 v4, v4, v5
    s_cbranch_vccz L_sd46
    s_sub_u32 s79, s79, 1
    s_cbranch_scc1 L_mi48
L_sc47:
    s_sub_u32 s31, s31, 64
    s_cbranch_scc0 L_sp45
    s_mov_b32 s31, 0
L_sd46:
    ds_write_b32 v3, v4
    s_waitcnt lgkmcnt(0)
    s_barrier
    s_branch L_fin
L_red2:
    s_cmp_ge_u32 s69, 28
    s_cbranch_scc1 L_watch
    s_cmp_ge_u32 s53, 8
    s_cbranch_scc1 L_fin
    v_and_b32 v5, 15, v0
    v_lshrrev_b32 v6, 4, v0
    v_lshl_add_u32 v5, v6, 1, v5
    v_mov_b32 v6, 163008
    v_lshl_add_u32 v13, v5, 2, v6
    s_sub_u32 s52, s53, 4
    s_mul_i32 s52, s52, 32
    v_add_u32 v11, s52, v13
    s_barrier
    s_barrier
    s_sleep 21
    s_add_u32 s71, s70, 118784
    s_mov_b64 s[56:57], -1
    s_mov_b64 vcc, -1
L_sp49:
    s_mov_b64 exec, s[56:57]
    buffer_load_dwordx4 v[16:19], v14, s[40:43], s70 offen sc1
    s_mov_b64 exec, vcc
    buffer_load_dwordx4 v[20:23], v14, s[40:43], s71 offen sc1
    s_mov_b64 exec, -1
    s_waitcnt vmcnt(1)
    v_xor_b32 v12, s72, v16
    v_bitop3_b32 v12, v12, v17, s73 bitop3:0xf6
    v_bitop3_b32 v12, v12, v18, s74 bitop3:0xf6
    v_bitop3_b32 v12, v12, v19, s75 bitop3:0xf6
    v_and_b32 v12, 0xff, v12
    v_cmp_ne_u32 s[56:57], 0, v12
    s_waitcnt vmcnt(0)
    v_xor_b32 v10, s72, v20
    v_bitop3_b32 v10, v10, v21, s73 bitop3:0xf6
    v_bitop3_b32 v10, v10, v22, s74 bitop3:0xf6
    v_bitop3_b32 v10, v10, v23, s75 bitop3:0xf6
    v_and_b32 v10, 0xff, v10
    v_cmp_ne_u32 vcc, 0, v10
    s_or_b64 s[58:59], s[56:57], vcc
    s_cbranch_scc0 L_sd50
    s_sub_u32 s79, s79, 1
    s_cbranch_scc1 L_mi52
L_sc51:
    s_sub_u32 s31, s31, 64
    s_cbranch_scc0 L_sp49
    s_mov_b32 s31, 0
L_sd50:
    v_xor_b32 v16, s72, v16
    v_xor_b32 v17, s73, v17
    v_xor_b32 v18, s74, v18
    v_xor_b32 v19, s75, v19
    v_xor_b32 v20, s72, v20
    v_xor_b32 v21, s73, v21
    v_xor_b32 v22, s74, v22
    v_xor_b32 v23, s75, v23
    v_pk_add_f32 v[16:17], v[16:17], v[20:21]
    v_pk_add_f32 v[18:19], v[18:19], v[22:23]
    s_nop 1
    v_permlane32_swap_b32 v16, v17
    v_permlane32_swap_b32 v18, v19
    v_add_f32 v4, v16, v17
    v_add_f32 v5, v18, v19
    v_lshlrev_b32 v9, 16, v9
    s_nop 0
    v_permlane16_swap_b32 v4, v5
    v_add_f32 v4, v4, v5
    s_nop 1
    v_add_f32_dpp v4, v4, v4 row_ror:8 row_mask:0xf bank_mask:0xf
    s_nop 1
    v_add_f32_dpp v4, v4, v4 row_ror:4 row_mask:0xf bank_mask:0xf
    s_nop 1
    v_add_f32_dpp v4, v4, v4 row_ror:2 row_mask:0xf bank_mask:0xf
    s_mov_b32 exec_lo, 196611
    s_mov_b32 exec_hi, 196611
    ds_write_b32 v11, v4
    s_waitcnt lgkmcnt(0)
    s_barrier
    s_cmp_lg_u32 s53, 4
    s_cbranch_scc1 L_fin
    ds_read_b32 v21, v13 offset:32
    ds_read_b32 v22, v13 offset:64
    ds_read_b32 v23, v13 offset:96
    v_add_f32 v4, v4, v9
    s_waitcnt lgkmcnt(0)
    v_add_f32 v4, v4, v21
    v_add_f32 v4, v4, v22
    v_add_f32 v4, v4, v23
    v_cvt_pk_bf16_f32 v4, v4, v4
    buffer_store_short v4, v15, s[48:51], 0 offen
    s_cmp_lg_u32 s2, 0
    s_cbranch_scc1 L_fin
    s_mov_b64 exec, 1
    v_mov_b32 v4, s30
    v_mov_b32 v5, 0
    buffer_store_dword v4, v5, s[40:43], 0 offen
L_fin:
    s_mov_b64 exec, -1
    s_endpgm
.p2align 8
L_w1:
    s_lshr_b32 s52, s2, 6
    s_lshl3_add_u32 s55, s52, s28
    s_cmp_ge_u32 s55, 28
    s_cbranch_scc1 L_w23
    s_setprio 3
    v_lshrrev_b32 v1, 3, v0
    v_and_b32 v8, 7, v0
    s_movk_i32 s46, 1792
    s_lshl_b32 s47, 1, 17
    s_mov_b32 s35, s47
    v_lshlrev_b32 v9, 4, v0
    v_cmp_gt_u32 vcc, 56, v0
    v_bfrev_b32 v10, 2
    s_nop 0
    v_cndmask_b32 v10, v10, v9, vcc
    v_and_b32 v4, 2, v1
    v_xor_b32 v4, v4, v8
    v_lshlrev_b32 v4, 4, v4
    s_mov_b32 s34, 1605632
    s_mov_b64 s[38:39], s[34:35]
    s_movk_i32 s52, 3584
    v_mad_u32_u24 v4, v1, s52, v4
    s_lshl_b32 s62, s52, 3
    s_bfe_u32 s53, s2, 0x30003
    s_mul_i32 s53, s53, 56
    s_mul_i32 s54, s53, s52
    s_lshl_b32 s55, s55, 7
    s_add_u32 s54, s54, s55
    s_mov_b32 m0, 145408
    s_mov_b32 s63, 6
    s_waitcnt lgkmcnt(0)
    s_mov_b64 s[44:45], s[4:5]
    s_mov_b64 s[32:33], s[16:17]
    s_mov_b64 s[36:37], s[18:19]
    buffer_load_dwordx4 v[16:19], v10, s[44:47], 0 offen
    buffer_load_dwordx4 v[20:23], v10, s[44:47], 0 offen offset:896
L_l1:
    buffer_load_dwordx4 v4, s[32:35], s54 offen nt lds
    s_addk_i32 m0, 7168
    s_sub_u32 s63, s63, 1
    buffer_load_dwordx4 v4, s[36:39], s54 offen nt lds
    s_cbranch_scc1 L_e1
    s_addk_i32 m0, -6144
    s_add_u32 s54, s54, s62
    v_xor_b32 v4, 64, v4
    s_branch L_l1
L_e1:
    s_barrier
    s_lshr_b32 s29, s2, 3
    s_mov_b32 s31, 0x100000
    s_mov_b32 s42, 1073741824
    s_mov_b32 s43, 0x20000
    s_mov_b32 s98, 2097152
    s_mov_b32 s99, 0x20000
    s_movk_i32 s79, 100
    v_mov_b32 v3, 163232
    s_and_b32 s100, s29, 24
    s_add_u32 s100, s100, s28
    s_and_b32 s101, s29, 7
    s_movk_i32 s61, 0x400
    s_mov_b32 s50, 1605632
    s_mov_b32 s51, 0x20000
    s_mov_b64 s[48:49], s[20:21]
    s_branch L_ln
.p2align 8
L_w0:
    s_setprio 3
    v_lshrrev_b32 v1, 3, v0
    v_and_b32 v8, 7, v0
    s_movk_i32 s46, 1792
    s_lshl_b32 s47, 1, 17
    s_mov_b32 s35, s47
    v_lshlrev_b32 v9, 4, v0
    v_cmp_gt_u32 vcc, 56, v0
    v_bfrev_b32 v10, 2
    s_nop 0
    v_cndmask_b32 v10, v10, v9, vcc
    v_and_b32 v4, 2, v1
    v_xor_b32 v4, v4, v8
    v_lshlrev_b32 v4, 4, v4
    s_mov_b32 s34, 3670016
    v_lshl_or_b32 v4, v1, 13, v4
    v_xor_b32 v5, 64, v4
    s_lshr_b32 s53, s2, 6
    s_mulk_i32 s53, 112
    s_lshl_b32 s54, s53, 13
    s_lshl_b32 s55, s28, 10
    s_add_u32 s54, s54, s55
    s_bfe_u32 s55, s2, 0x30003
    s_lshl_b32 s55, s55, 7
    s_add_u32 s54, s54, s55
    s_mov_b32 m0, 131072
    s_lshl_b32 s62, 1, 16
    s_mov_b32 s63, 6
    s_waitcnt lgkmcnt(0)
    s_mov_b64 s[44:45], s[4:5]
    s_mov_b64 s[32:33], s[10:11]
    buffer_load_dwordx4 v[16:19], v10, s[44:47], 0 offen
    buffer_load_dwordx4 v[20:23], v10, s[44:47], 0 offen offset:896
L_l0:
    buffer_load_dwordx4 v4, s[32:35], s54 offen nt lds
    s_addk_i32 m0, 0x400
    s_add_u32 s54, s54, s62
    buffer_load_dwordx4 v5, s[32:35], s54 offen nt lds
    s_addk_i32 m0, 0x400
    s_add_u32 s54, s54, s62
    s_sub_u32 s63, s63, 1
    s_cbranch_scc0 L_l0
    s_barrier
    s_lshr_b32 s29, s2, 3
    s_mov_b32 s31, 0x100000
    s_mov_b32 s42, 1073741824
    s_mov_b32 s43, 0x20000
    s_mov_b32 s98, 2097152
    s_mov_b32 s99, 0x20000
    s_movk_i32 s79, 100
    v_mov_b32 v3, 163232
    s_and_b32 s100, s29, 24
    s_add_u32 s100, s100, s28
    s_and_b32 s101, s29, 7
    s_movk_i32 s61, 0x400
    s_mov_b32 s38, 3670016
    s_mov_b32 s39, 0x20000
    s_mov_b64 s[36:37], s[12:13]
L_ln:
    s_mov_b64 s[40:41], s[26:27]
    s_mov_b64 s[96:97], s[26:27]
    s_load_dword s30, s[26:27], 0
    s_waitcnt vmcnt(14)
    v_lshlrev_b32 v24, 16, v16
    v_and_b32 v25, 0xffff0000, v16
    v_lshlrev_b32 v26, 16, v17
    v_and_b32 v27, 0xffff0000, v17
    v_lshlrev_b32 v28, 16, v18
    v_and_b32 v29, 0xffff0000, v18
    v_lshlrev_b32 v30, 16, v19
    v_and_b32 v31, 0xffff0000, v19
    v_lshlrev_b32 v32, 16, v20
    v_and_b32 v33, 0xffff0000, v20
    v_lshlrev_b32 v34, 16, v21
    v_and_b32 v35, 0xffff0000, v21
    v_lshlrev_b32 v36, 16, v22
    v_and_b32 v37, 0xffff0000, v22
    v_lshlrev_b32 v38, 16, v23
    v_and_b32 v39, 0xffff0000, v23
    v_pk_add_f32 v[40:41], v[24:25], v[26:27]
    v_pk_add_f32 v[42:43], v[28:29], v[30:31]
    v_pk_add_f32 v[44:45], v[32:33], v[34:35]
    v_pk_add_f32 v[46:47], v[36:37], v[38:39]
    v_pk_add_f32 v[40:41], v[40:41], v[42:43]
    v_pk_add_f32 v[44:45], v[44:45], v[46:47]
    v_add_f32 v11, v40, v41
    v_add_f32 v12, v44, v45
    s_nop 1
    v_permlane32_swap_b32 v11, v12
    v_add_f32 v11, v11, v12
    v_mov_b32 v12, v11
    s_nop 1
    v_permlane16_swap_b32 v11, v12
    v_add_f32 v11, v11, v12
    s_nop 1
    v_add_f32_dpp v11, v11, v11 row_ror:8 row_mask:0xf bank_mask:0xf
    s_nop 1
    v_add_f32_dpp v11, v11, v11 row_ror:4 row_mask:0xf bank_mask:0xf
    s_nop 1
    v_add_f32_dpp v11, v11, v11 row_ror:2 row_mask:0xf bank_mask:0xf
    s_nop 1
    v_add_f32_dpp v11, v11, v11 row_ror:1 row_mask:0xf bank_mask:0xf
    v_mul_f32 v11, 0x3b124925, v11
    s_nop 0
    v_readlane_b32 s56, v11, 0
    v_readlane_b32 s57, v11, 32
    v_cvt_pk_bf16_f32 v13, v11, v11
    v_subrev_f32 v40, s56, v24
    v_subrev_f32 v41, s56, v25
    v_subrev_f32 v42, s56, v26
    v_subrev_f32 v43, s56, v27
    v_subrev_f32 v44, s56, v28
    v_subrev_f32 v45, s56, v29
    v_subrev_f32 v46, s56, v30
    v_subrev_f32 v47, s56, v31
    v_subrev_f32 v48, s57, v32
    v_subrev_f32 v49, s57, v33
    v_subrev_f32 v50, s57, v34
    v_subrev_f32 v51, s57, v35
    v_subrev_f32 v52, s57, v36
    v_subrev_f32 v53, s57, v37
    v_subrev_f32 v54, s57, v38
    v_subrev_f32 v55, s57, v39
    v_mul_f32 v11, v40, v40
    v_mul_f32 v12, v48, v48
    v_fmac_f32 v11, v41, v41
    v_fmac_f32 v12, v49, v49
    v_fmac_f32 v11, v42, v42
    v_fmac_f32 v12, v50, v50
    v_fmac_f32 v11, v43, v43
    v_fmac_f32 v12, v51, v51
    v_fmac_f32 v11, v44, v44
    v_fmac_f32 v12, v52, v52
    v_fmac_f32 v11, v45, v45
    v_fmac_f32 v12, v53, v53
    v_fmac_f32 v11, v46, v46
    v_fmac_f32 v12, v54, v54
    v_fmac_f32 v11, v47, v47
    v_fmac_f32 v12, v55, v55
    v_cndmask_b32 v11, 0, v11, vcc
    v_cndmask_b32 v12, 0, v12, vcc
    v_lshlrev_b32 v13, 16, v13
    s_nop 0
    v_permlane32_swap_b32 v11, v12
    v_add_f32 v11, v11, v12
    v_mov_b32 v12, v11
    s_nop 1
    v_permlane16_swap_b32 v11, v12
    v_add_f32 v11, v11, v12
    s_nop 1
    v_add_f32_dpp v11, v11, v11 row_ror:8 row_mask:0xf bank_mask:0xf
    s_nop 1
    v_add_f32_dpp v11, v11, v11 row_ror:4 row_mask:0xf bank_mask:0xf
    s_nop 1
    v_add_f32_dpp v11, v11, v11 row_ror:2 row_mask:0xf bank_mask:0xf
    s_nop 1
    v_add_f32_dpp v11, v11, v11 row_ror:1 row_mask:0xf bank_mask:0xf
    v_mul_f32 v11, 0x3b124925, v11
    v_readlane_b32 s56, v13, 0
    v_readlane_b32 s57, v13, 32
    v_cvt_pk_bf16_f32 v11, v11, v11
    v_lshlrev_b32 v11, 16, v11
    v_add_f32 v11, 0x3727c5ac, v11
    v_cvt_pk_bf16_f32 v11, v11, v11
    v_lshlrev_b32 v11, 16, v11
    v_sqrt_f32 v11, v11
    s_nop 0
    v_cvt_pk_bf16_f32 v11, v11, v11
    v_lshlrev_b32 v11, 16, v11
    v_rcp_f32 v11, v11
    v_subrev_f32 v24, s56, v24
    v_subrev_f32 v25, s56, v25
    v_subrev_f32 v26, s56, v26
    v_subrev_f32 v27, s56, v27
    v_subrev_f32 v28, s56, v28
    v_subrev_f32 v29, s56, v29
    v_subrev_f32 v30, s56, v30
    v_subrev_f32 v31, s56, v31
    v_subrev_f32 v32, s57, v32
    v_subrev_f32 v33, s57, v33
    v_subrev_f32 v34, s57, v34
    v_subrev_f32 v35, s57, v35
    v_subrev_f32 v36, s57, v36
    v_subrev_f32 v37, s57, v37
    v_subrev_f32 v38, s57, v38
    v_subrev_f32 v39, s57, v39
    v_readlane_b32 s58, v11, 0
    v_readlane_b32 s59, v11, 32
    v_cvt_pk_bf16_f32 v16, v24, v25
    v_cvt_pk_bf16_f32 v17, v26, v27
    v_cvt_pk_bf16_f32 v18, v28, v29
    v_cvt_pk_bf16_f32 v19, v30, v31
    v_cvt_pk_bf16_f32 v20, v32, v33
    v_cvt_pk_bf16_f32 v21, v34, v35
    v_cvt_pk_bf16_f32 v22, v36, v37
    v_cvt_pk_bf16_f32 v23, v38, v39
    v_lshlrev_b32 v24, 16, v16
    v_and_b32 v25, 0xffff0000, v16
    v_lshlrev_b32 v26, 16, v17
    v_and_b32 v27, 0xffff0000, v17
    v_lshlrev_b32 v28, 16, v18
    v_and_b32 v29, 0xffff0000, v18
    v_lshlrev_b32 v30, 16, v19
    v_and_b32 v31, 0xffff0000, v19
    v_lshlrev_b32 v32, 16, v20
    v_and_b32 v33, 0xffff0000, v20
    v_lshlrev_b32 v34, 16, v21
    v_and_b32 v35, 0xffff0000, v21
    v_lshlrev_b32 v36, 16, v22
    v_and_b32 v37, 0xffff0000, v22
    v_lshlrev_b32 v38, 16, v23
    v_and_b32 v39, 0xffff0000, v23
    v_mul_f32 v24, s58, v24
    v_mul_f32 v25, s58, v25
    v_mul_f32 v26, s58, v26
    v_mul_f32 v27, s58, v27
    v_mul_f32 v28, s58, v28
    v_mul_f32 v29, s58, v29
    v_mul_f32 v30, s58, v30
    v_mul_f32 v31, s58, v31
    v_mul_f32 v32, s59, v32
    v_mul_f32 v33, s59, v33
    v_mul_f32 v34, s59, v34
    v_mul_f32 v35, s59, v35
    v_mul_f32 v36, s59, v36
    v_mul_f32 v37, s59, v37
    v_mul_f32 v38, s59, v38
    v_mul_f32 v39, s59, v39
    v_cvt_pk_bf16_f32 v16, v24, v25
    v_cvt_pk_bf16_f32 v17, v26, v27
    v_cvt_pk_bf16_f32 v18, v28, v29
    v_cvt_pk_bf16_f32 v19, v30, v31
    v_cvt_pk_bf16_f32 v20, v32, v33
    v_cvt_pk_bf16_f32 v21, v34, v35
    v_cvt_pk_bf16_f32 v22, v36, v37
    v_cvt_pk_bf16_f32 v23, v38, v39
    v_add_u32 v9, 160896, v9
    ds_write_b128 v9, v[16:19]
    ds_write_b128 v9, v[20:23] offset:1024
    v_lshrrev_b32 v1, 4, v0
    v_and_b32 v11, 1, v0
    v_lshlrev_b32 v11, 10, v11
    s_lshl_b32 s53, s53, 1
    s_add_u32 s53, s53, 160896
    v_add_u32 v11, s53, v11
    v_lshl_add_u32 v12, v1, 3, v11
    v_lshl_add_u32 v11, v1, 4, v11
    v_bfe_u32 v13, v0, 2, 2
    v_and_b32 v14, 3, v0
    v_lshlrev_b32 v14, 3, v14
    v_lshl_or_b32 v14, v13, 7, v14
    v_lshrrev_b32 v13, 1, v13
    v_lshl_or_b32 v14, v13, 5, v14
    v_and_b32 v13, 1, v1
    v_lshlrev_b32 v15, 10, v1
    v_lshl_or_b32 v15, v13, 6, v15
    v_or_b32 v15, v15, v14
    v_lshrrev_b32 v6, 1, v1
    v_lshlrev_b32 v7, 9, v1
    v_lshl_or_b32 v7, v6, 6, v7
    v_or_b32 v7, v7, v14
    s_mov_b32 s64, 0xffff0000
    s_mov_b32 s65, 0
    s_mov_b32 s66, 0
    s_mov_b32 s67, 0xffff
    s_mov_b32 s68, 0
    s_mov_b32 s69, 0xffff0000
    s_cmp_eq_u32 s3, 1
    s_cbranch_scc1 L_h1b
    ds_read_b128 v[16:19], v11 offset:0
    ds_read_b128 v[20:23], v11 offset:64
    ds_read_b128 v[24:27], v11 offset:128
    ds_read_b64 v[28:29], v12 offset:192
    v_add_u32 v15, 131072, v15
    v_add_u32 v7, 143360, v7
    s_waitcnt vmcnt(0)
    v_xor_b32 v4, 0, v15
    v_xor_b32 v5, 0, v7
    ds_read_b64_tr_b16 v[32:33], v4 offset:0
    ds_read_b64_tr_b16 v[34:35], v4 offset:512
    ds_read_b64_tr_b16 v[36:37], v4 offset:4096
    ds_read_b64_tr_b16 v[38:39], v4 offset:4608
    ds_read_b64_tr_b16 v[40:41], v4 offset:8192
    ds_read_b64_tr_b16 v[42:43], v4 offset:8704
    ds_read_b64_tr_b16 v[44:45], v5
    v_xor_b32 v4, 32, v15
    v_xor_b32 v5, 32, v7
    ds_read_b64_tr_b16 v[46:47], v4 offset:0
    ds_read_b64_tr_b16 v[48:49], v4 offset:512
    ds_read_b64_tr_b16 v[50:51], v4 offset:4096
    ds_read_b64_tr_b16 v[52:53], v4 offset:4608
    ds_read_b64_tr_b16 v[54:55], v4 offset:8192
    ds_read_b64_tr_b16 v[56:57], v4 offset:8704
    ds_read_b64_tr_b16 v[58:59], v5
    v_xor_b32 v4, 64, v15
    v_xor_b32 v5, 64, v7
    ds_read_b64_tr_b16 v[60:61], v4 offset:0
    ds_read_b64_tr_b16 v[62:63], v4 offset:512
    ds_read_b64_tr_b16 v[64:65], v4 offset:4096
    ds_read_b64_tr_b16 v[66:67], v4 offset:4608
    ds_read_b64_tr_b16 v[68:69], v4 offset:8192
    ds_read_b64_tr_b16 v[70:71], v4 offset:8704
    ds_read_b64_tr_b16 v[72:73], v5
    v_xor_b32 v4, 96, v15
    v_xor_b32 v5, 96, v7
    ds_read_b64_tr_b16 v[74:75], v4 offset:0
    ds_read_b64_tr_b16 v[76:77], v4 offset:512
    ds_read_b64_tr_b16 v[78:79], v4 offset:4096
    ds_read_b64_tr_b16 v[80:81], v4 offset:4608
    ds_read_b64_tr_b16 v[82:83], v4 offset:8192
    ds_read_b64_tr_b16 v[84:85], v4 offset:8704
    ds_read_b64_tr_b16 v[86:87], v5
    s_lshl_b32 s52, s28, 3
    s_lshr_b32 s54, s29, 3
    s_add_u32 s52, s52, s54
    s_lshl_b32 s52, s52, 11
    s_and_b32 s54, s29, 7
    s_lshl_b32 s54, s54, 8
    s_add_u32 s52, s52, s54
    s_add_u32 s56, s52, 16384
    v_and_b32 v6, 1, v0
    v_lshlrev_b32 v6, 13, v6
    v_bfe_u32 v4, v0, 1, 2
    v_lshl_or_b32 v6, v4, 6, v6
    v_lshl_or_b32 v6, v1, 4, v6
    v_mov_b32 v9, 0xffffff00
    s_mov_b32 s64, 0x0c0c0c0c
    s_mov_b32 s65, s64
    s_mov_b32 s66, 0x30303030
    s_mov_b32 s67, s66
    s_mov_b32 s68, 0xc0c0c0c0
    s_mov_b32 s69, s68
    s_waitcnt lgkmcnt(0)
    s_add_u32 s30, s30, 2654435769
    s_and_b32 s72, s30, 0xff
    s_bfe_u32 s73, s30, 0x80008
    s_bfe_u32 s74, s30, 0x80010
    s_lshr_b32 s75, s30, 24
    v_mfma_f32_16x16x32_bf16 v[96:99], v[32:35], v[16:19], 0
    v_mfma_f32_16x16x32_bf16 v[100:103], v[46:49], v[16:19], 0
    v_mfma_f32_16x16x32_bf16 v[104:107], v[60:63], v[16:19], 0
    v_mfma_f32_16x16x32_bf16 v[108:111], v[74:77], v[16:19], 0
    v_mfma_f32_16x16x32_bf16 v[96:99], v[36:39], v[20:23], v[96:99]
    v_mfma_f32_16x16x32_bf16 v[100:103], v[50:53], v[20:23], v[100:103]
    v_mfma_f32_16x16x32_bf16 v[104:107], v[64:67], v[20:23], v[104:107]
    v_mfma_f32_16x16x32_bf16 v[108:111], v[78:81], v[20:23], v[108:111]
    v_mfma_f32_16x16x32_bf16 v[96:99], v[40:43], v[24:27], v[96:99]
    v_mfma_f32_16x16x32_bf16 v[100:103], v[54:57], v[24:27], v[100:103]
    v_mfma_f32_16x16x32_bf16 v[104:107], v[68:71], v[24:27], v[104:107]
    v_mfma_f32_16x16x32_bf16 v[108:111], v[82:85], v[24:27], v[108:111]
    v_mfma_f32_16x16x16_bf16 v[96:99], v[44:45], v[28:29], v[96:99]
    v_mfma_f32_16x16x16_bf16 v[100:103], v[58:59], v[28:29], v[100:103]
    v_mfma_f32_16x16x16_bf16 v[104:107], v[72:73], v[28:29], v[104:107]
    v_mfma_f32_16x16x16_bf16 v[108:111], v[86:87], v[28:29], v[108:111]
    s_nop 5
    v_cndmask_b32 v16, v96, v100, s[64:65]
    v_cndmask_b32 v16, v16, v104, s[66:67]
    v_cndmask_b32 v16, v16, v108, s[68:69]
    v_cndmask_b32 v17, v97, v101, s[64:65]
    v_cndmask_b32 v17, v17, v105, s[66:67]
    v_cndmask_b32 v17, v17, v109, s[68:69]
    v_cndmask_b32 v18, v98, v102, s[64:65]
    v_cndmask_b32 v18, v18, v106, s[66:67]
    v_cndmask_b32 v18, v18, v110, s[68:69]
    v_cndmask_b32 v19, v99, v103, s[64:65]
    v_cndmask_b32 v19, v19, v107, s[66:67]
    v_cndmask_b32 v19, v19, v111, s[68:69]
    v_and_or_b32 v16, v16, v9, s72
    v_and_or_b32 v17, v17, v9, s73
    v_and_or_b32 v18, v18, v9, s74
    v_and_or_b32 v19, v19, v9, s75
    s_mov_b32 exec_lo, 0x00ff00ff
    s_mov_b32 exec_hi, 0x00ff00ff
    buffer_store_dwordx4 v[16:19], v6, s[40:43], s56 offen
    s_mov_b64 exec, -1
    s_mov_b64 exec, 1
    v_mov_b32 v2, 1
    ds_write_b32 v3, v2 offset:16
    s_mov_b64 exec, -1
    s_lshl_b32 s52, s28, 9
    s_lshr_b32 s54, s29, 2
    s_lshl_b32 s54, s54, 5
    s_add_u32 s52, s52, s54
    s_and_b32 s54, s29, 3
    s_lshl_b32 s54, s54, 1
    s_add_u32 s52, s52, s54
    s_mul_i32 s53, s52, 896
    v_lshlrev_b32 v4, 4, v0
    s_mov_b32 m0, 131072
    s_movk_i32 s61, 928
    v_bfe_u32 v7, v0, 2, 2
    v_and_b32 v5, 3, v0
    v_lshlrev_b32 v5, 3, v5
    s_mul_i32 s52, s3, 224
    v_add_u32 v5, s52, v5
    s_movk_i32 s52, 928
    v_mad_u32_u24 v6, v7, s52, v5
    v_add_u32 v6, 145920, v6
    v_lshrrev_b32 v9, 1, v7
    v_and_b32 v7, 1, v7
    v_lshl_or_b32 v9, v9, 2, v7
    v_bfe_u32 v7, v0, 4, 1
    v_lshl_or_b32 v9, v7, 1, v9
    v_mad_u32_u24 v5, v9, s52, v5
    v_add_u32 v5, 131072, v5
    v_mov_b32 v124, 0
    v_mov_b32 v125, 0
    v_mov_b32 v126, 0
    v_mov_b32 v127, 0
    s_cmp_ge_u32 s100, 28
    s_cbranch_scc1 L_nf53
L_sp54:
    ds_read_b32 v2, v3 offset:24
    s_waitcnt lgkmcnt(0)
    v_readfirstlane_b32 s52, v2
    s_cmp_eq_u32 s52, 1
    s_cbranch_scc1 L_sd55
    s_sleep 2
    s_sub_u32 s31, s31, 1
    s_cbranch_scc0 L_sp54
    s_mov_b32 s31, 0
L_sd55:
    v_bfe_u32 v7, v0, 3, 1
    v_lshlrev_b32 v7, 4, v7
    v_add_u32 v7, 163200, v7
    ds_read_b128 v[16:19], v7
    s_mov_b32 s57, 0
    s_waitcnt lgkmcnt(0)
    s_mov_b32 s56, 257
    v_cndmask_b32 v128, 0, v16, s[56:57]
    v_cndmask_b32 v129, 0, v17, s[56:57]
    v_cndmask_b32 v130, 0, v18, s[56:57]
    v_cndmask_b32 v131, 0, v19, s[56:57]
    s_mov_b32 s56, 514
    v_cndmask_b32 v132, 0, v16, s[56:57]
    v_cndmask_b32 v133, 0, v17, s[56:57]
    v_cndmask_b32 v134, 0, v18, s[56:57]
    v_cndmask_b32 v135, 0, v19, s[56:57]
    s_mov_b32 s56, 1028
    v_cndmask_b32 v136, 0, v16, s[56:57]
    v_cndmask_b32 v137, 0, v17, s[56:57]
    v_cndmask_b32 v138, 0, v18, s[56:57]
    v_cndmask_b32 v139, 0, v19, s[56:57]
    s_mov_b32 s56, 2056
    v_cndmask_b32 v140, 0, v16, s[56:57]
    v_cndmask_b32 v141, 0, v17, s[56:57]
    v_cndmask_b32 v142, 0, v18, s[56:57]
    v_cndmask_b32 v143, 0, v19, s[56:57]
    s_mov_b32 s56, 4112
    v_cndmask_b32 v144, 0, v16, s[56:57]
    v_cndmask_b32 v145, 0, v17, s[56:57]
    v_cndmask_b32 v146, 0, v18, s[56:57]
    v_cndmask_b32 v147, 0, v19, s[56:57]
    s_mov_b32 s56, 8224
    v_cndmask_b32 v148, 0, v16, s[56:57]
    v_cndmask_b32 v149, 0, v17, s[56:57]
    v_cndmask_b32 v150, 0, v18, s[56:57]
    v_cndmask_b32 v151, 0, v19, s[56:57]
    s_mov_b32 s56, 16448
    v_cndmask_b32 v152, 0, v16, s[56:57]
    v_cndmask_b32 v153, 0, v17, s[56:57]
    v_cndmask_b32 v154, 0, v18, s[56:57]
    v_cndmask_b32 v155, 0, v19, s[56:57]
L_nf53:
    v_mov_b32 v1, 162944
    v_lshrrev_b32 v7, 4, v0
    v_lshl_add_u32 v1, v7, 4, v1
    v_bfe_u32 v7, v0, 3, 1
    v_mul_u32_u24 v7, 28, v7
    v_add_u32 v7, v7, v8
    s_mul_i32 s52, s3, 7
    v_add_u32 v7, s52, v7
    v_lshrrev_b32 v10, 4, v0
    v_lshl_or_b32 v7, v7, 2, v10
    v_lshrrev_b32 v10, 1, v7
    s_movk_i32 s52, 32
    v_mul_u32_u24 v10, s52, v10
    v_and_b32 v7, 1, v7
    v_lshl_add_u32 v9, v7, 4, v10
    s_mul_i32 s58, s2, 3712
    s_add_u32 s58, s58, 983040
    v_mov_b32 v15, 0xffffff00
    s_mov_b32 s62, 65537
    s_mov_b32 s63, 16777472
    s_mov_b32 s64, 131074
    s_mov_b32 s65, 33554944
    s_mov_b32 s66, 262148
    s_mov_b32 s67, 67109888
    s_mov_b32 s68, 524296
    s_mov_b32 s69, 134219776
    s_mov_b32 s70, 1048592
    s_mov_b32 s71, 268439552
    s_mov_b32 s76, 2097184
    s_mov_b32 s77, 536879104
    s_mov_b32 s54, 4194368
    s_mov_b32 s55, 1073758208
L_sp56:
    ds_read_b32 v2, v3 offset:20
    s_waitcnt lgkmcnt(0)
    v_readfirstlane_b32 s52, v2
    s_cmp_eq_u32 s52, 8
    s_cbranch_scc1 L_sd57
    s_sleep 2
    s_sub_u32 s31, s31, 1
    s_cbranch_scc0 L_sp56
    s_mov_b32 s31, 0
L_sd57:
    s_mov_b32 exec_hi, 0xffffff
    buffer_load_dwordx4 v4, s[36:39], s53 offen nt lds
    s_add_u32 m0, m0, s61
    s_add_u32 s60, s53, 7168
    buffer_load_dwordx4 v4, s[36:39], s60 offen nt lds
    s_add_u32 m0, m0, s61
    s_add_u32 s60, s53, 14336
    buffer_load_dwordx4 v4, s[36:39], s60 offen nt lds
    s_add_u32 m0, m0, s61
    s_add_u32 s60, s53, 21504
    buffer_load_dwordx4 v4, s[36:39], s60 offen nt lds
    s_add_u32 m0, m0, s61
    s_add_u32 s60, s53, 229376
    buffer_load_dwordx4 v4, s[36:39], s60 offen nt lds
    s_add_u32 m0, m0, s61
    s_add_u32 s60, s53, 236544
    buffer_load_dwordx4 v4, s[36:39], s60 offen nt lds
    s_add_u32 m0, m0, s61
    s_add_u32 s60, s53, 243712
    buffer_load_dwordx4 v4, s[36:39], s60 offen nt lds
    s_add_u32 m0, m0, s61
    s_add_u32 s60, s53, 250880
    buffer_load_dwordx4 v4, s[36:39], s60 offen nt lds
    s_add_u32 m0, m0, s61
    s_add_u32 s60, s53, 896
    buffer_load_dwordx4 v4, s[36:39], s60 offen nt lds
    s_add_u32 m0, m0, s61
    s_add_u32 s60, s53, 8064
    buffer_load_dwordx4 v4, s[36:39], s60 offen nt lds
    s_add_u32 m0, m0, s61
    s_add_u32 s60, s53, 15232
    buffer_load_dwordx4 v4, s[36:39], s60 offen nt lds
    s_add_u32 m0, m0, s61
    s_add_u32 s60, s53, 22400
    buffer_load_dwordx4 v4, s[36:39], s60 offen nt lds
    s_add_u32 m0, m0, s61
    s_add_u32 s60, s53, 230272
    buffer_load_dwordx4 v4, s[36:39], s60 offen nt lds
    s_add_u32 m0, m0, s61
    s_add_u32 s60, s53, 237440
    buffer_load_dwordx4 v4, s[36:39], s60 offen nt lds
    s_add_u32 m0, m0, s61
    s_add_u32 s60, s53, 244608
    buffer_load_dwordx4 v4, s[36:39], s60 offen nt lds
    s_add_u32 m0, m0, s61
    s_add_u32 s60, s53, 251776
    buffer_load_dwordx4 v4, s[36:39], s60 offen nt lds
    s_mov_b64 exec, -1
    s_barrier
    s_branch L_prep
L_h1b:
    ds_read_b128 v[16:19], v11
    ds_read_b64 v[20:21], v12 offset:64
    v_lshlrev_b32 v13, 3, v6
    v_lshlrev_b32 v13, 1, v13
    v_sub_u32 v12, v12, v13
    ds_read_b64 v[22:23], v12 offset:96
    v_and_b32 v13, 1, v1
    v_lshl_or_b32 v14, v13, 9, v14
    v_add_u32 v15, 145408, v15
    v_add_u32 v7, 149504, v7
    v_add_u32 v14, 151552, v14
    s_waitcnt vmcnt(0)
    v_xor_b32 v4, 0, v15
    v_xor_b32 v5, 0, v7
    v_xor_b32 v6, 0, v14
    ds_read_b64_tr_b16 v[32:33], v4 offset:0
    ds_read_b64_tr_b16 v[34:35], v4 offset:512
    ds_read_b64_tr_b16 v[36:37], v5 offset:0
    ds_read_b64_tr_b16 v[38:39], v6 offset:0
    ds_read_b64_tr_b16 v[64:65], v4 offset:7168
    ds_read_b64_tr_b16 v[66:67], v4 offset:7680
    ds_read_b64_tr_b16 v[68:69], v5 offset:7168
    ds_read_b64_tr_b16 v[70:71], v6 offset:7168
    v_xor_b32 v4, 32, v15
    v_xor_b32 v5, 32, v7
    v_xor_b32 v6, 32, v14
    ds_read_b64_tr_b16 v[40:41], v4 offset:0
    ds_read_b64_tr_b16 v[42:43], v4 offset:512
    ds_read_b64_tr_b16 v[44:45], v5 offset:0
    ds_read_b64_tr_b16 v[46:47], v6 offset:0
    ds_read_b64_tr_b16 v[72:73], v4 offset:7168
    ds_read_b64_tr_b16 v[74:75], v4 offset:7680
    ds_read_b64_tr_b16 v[76:77], v5 offset:7168
    ds_read_b64_tr_b16 v[78:79], v6 offset:7168
    v_xor_b32 v4, 64, v15
    v_xor_b32 v5, 64, v7
    v_xor_b32 v6, 64, v14
    ds_read_b64_tr_b16 v[48:49], v4 offset:0
    ds_read_b64_tr_b16 v[50:51], v4 offset:512
    ds_read_b64_tr_b16 v[52:53], v5 offset:0
    ds_read_b64_tr_b16 v[54:55], v6 offset:0
    ds_read_b64_tr_b16 v[80:81], v4 offset:7168
    ds_read_b64_tr_b16 v[82:83], v4 offset:7680
    ds_read_b64_tr_b16 v[84:85], v5 offset:7168
    ds_read_b64_tr_b16 v[86:87], v6 offset:7168
    v_xor_b32 v4, 96, v15
    v_xor_b32 v5, 96, v7
    v_xor_b32 v6, 96, v14
    ds_read_b64_tr_b16 v[56:57], v4 offset:0
    ds_read_b64_tr_b16 v[58:59], v4 offset:512
    ds_read_b64_tr_b16 v[60:61], v5 offset:0
    ds_read_b64_tr_b16 v[62:63], v6 offset:0
    ds_read_b64_tr_b16 v[88:89], v4 offset:7168
    ds_read_b64_tr_b16 v[90:91], v4 offset:7680
    ds_read_b64_tr_b16 v[92:93], v5 offset:7168
    ds_read_b64_tr_b16 v[94:95], v6 offset:7168
    s_mov_b32 s56, -1
    s_mov_b32 s57, 0
    s_lshl_b32 s58, s28, 5
    s_add_u32 s58, s58, s29
    s_lshl_b32 s58, s58, 10
    s_add_u32 s58, s58, 147456
    v_lshlrev_b32 v6, 4, v0
    v_mov_b32 v9, 0xffffff00
    s_waitcnt lgkmcnt(0)
    v_cndmask_b32 v22, 0, v22, s[56:57]
    v_cndmask_b32 v23, 0, v23, s[56:57]
    v_mfma_f32_16x16x32_bf16 v[96:99], v[16:19], v[32:35], 0
    v_mfma_f32_16x16x32_bf16 v[100:103], v[16:19], v[40:43], 0
    v_mfma_f32_16x16x32_bf16 v[104:107], v[16:19], v[48:51], 0
    v_mfma_f32_16x16x32_bf16 v[108:111], v[16:19], v[56:59], 0
    v_mfma_f32_16x16x32_bf16 v[112:115], v[16:19], v[64:67], 0
    v_mfma_f32_16x16x32_bf16 v[116:119], v[16:19], v[72:75], 0
    v_mfma_f32_16x16x32_bf16 v[120:123], v[16:19], v[80:83], 0
    v_mfma_f32_16x16x32_bf16 v[124:127], v[16:19], v[88:91], 0
    v_mfma_f32_16x16x16_bf16 v[96:99], v[20:21], v[36:37], v[96:99]
    v_mfma_f32_16x16x16_bf16 v[100:103], v[20:21], v[44:45], v[100:103]
    v_mfma_f32_16x16x16_bf16 v[104:107], v[20:21], v[52:53], v[104:107]
    v_mfma_f32_16x16x16_bf16 v[108:111], v[20:21], v[60:61], v[108:111]
    v_mfma_f32_16x16x16_bf16 v[112:115], v[20:21], v[68:69], v[112:115]
    v_mfma_f32_16x16x16_bf16 v[116:119], v[20:21], v[76:77], v[116:119]
    v_mfma_f32_16x16x16_bf16 v[120:123], v[20:21], v[84:85], v[120:123]
    v_mfma_f32_16x16x16_bf16 v[124:127], v[20:21], v[92:93], v[124:127]
    v_mfma_f32_16x16x16_bf16 v[96:99], v[22:23], v[38:39], v[96:99]
    v_mfma_f32_16x16x16_bf16 v[100:103], v[22:23], v[46:47], v[100:103]
    v_mfma_f32_16x16x16_bf16 v[104:107], v[22:23], v[54:55], v[104:107]
    v_mfma_f32_16x16x16_bf16 v[108:111], v[22:23], v[62:63], v[108:111]
    v_mfma_f32_16x16x16_bf16 v[112:115], v[22:23], v[70:71], v[112:115]
    v_mfma_f32_16x16x16_bf16 v[116:119], v[22:23], v[78:79], v[116:119]
    v_mfma_f32_16x16x16_bf16 v[120:123], v[22:23], v[86:87], v[120:123]
    v_mfma_f32_16x16x16_bf16 v[124:127], v[22:23], v[94:95], v[124:127]
    s_add_u32 s30, s30, 2654435769
    s_and_b32 s72, s30, 0xff
    s_bfe_u32 s73, s30, 0x80008
    s_bfe_u32 s74, s30, 0x80010
    s_lshr_b32 s75, s30, 24
    v_cndmask_b32 v16, v96, v100, s[64:65]
    v_cndmask_b32 v16, v16, v104, s[66:67]
    v_cndmask_b32 v16, v16, v108, s[68:69]
    v_cndmask_b32 v17, v97, v101, s[64:65]
    v_cndmask_b32 v17, v17, v105, s[66:67]
    v_cndmask_b32 v17, v17, v109, s[68:69]
    v_cndmask_b32 v18, v112, v116, s[64:65]
    v_cndmask_b32 v18, v18, v120, s[66:67]
    v_cndmask_b32 v18, v18, v124, s[68:69]
    v_cndmask_b32 v19, v113, v117, s[64:65]
    v_cndmask_b32 v19, v19, v121, s[66:67]
    v_cndmask_b32 v19, v19, v125, s[68:69]
    v_and_or_b32 v16, v16, v9, s72
    v_and_or_b32 v17, v17, v9, s73
    v_and_or_b32 v18, v18, v9, s74
    v_and_or_b32 v19, v19, v9, s75
    buffer_store_dwordx4 v[16:19], v6, s[40:43], s58 offen
    v_lshrrev_b32 v1, 3, v0
    v_lshlrev_b32 v5, 10, v1
    v_lshl_or_b32 v5, v8, 4, v5
    s_lshl_b32 s54, s28, 5
    s_and_b32 s55, s29, 24
    s_add_u32 s54, s54, s55
    s_lshl_b32 s54, s54, 10
    s_lshl_b32 s55, s101, 7
    s_add_u32 s54, s54, s55
    s_add_u32 s54, s54, 147456
L_sp58:
    buffer_load_dwordx4 v[24:27], v5, s[96:99], s54 offen sc1
    s_waitcnt vmcnt(0)
    v_xor_b32 v24, s72, v24
    v_xor_b32 v25, s73, v25
    v_xor_b32 v26, s74, v26
    v_xor_b32 v27, s75, v27
    v_or3_b32 v12, v24, v25, v26
    v_or_b32 v12, v12, v27
    v_and_b32 v12, 0xff, v12
    v_cmp_ne_u32 vcc, 0, v12
    s_cbranch_vccz L_sd59
    s_sub_u32 s79, s79, 1
    s_cbranch_scc1 L_mi61
L_sc60:
    s_sleep 8
    s_sub_u32 s31, s31, 64
    s_cbranch_scc0 L_sp58
    s_mov_b32 s31, 0
L_sd59:
    v_permlane32_swap_b32 v24, v25
    v_permlane32_swap_b32 v26, v27
    v_add_f32 v24, v24, v25
    v_add_f32 v28, v26, v27
    v_mov_b32 v26, v24
    v_mov_b32 v30, v28
    s_nop 0
    v_permlane16_swap_b32 v24, v26
    v_permlane16_swap_b32 v28, v30
    v_add_f32 v24, v24, v26
    v_add_f32 v28, v28, v30
    s_nop 0
    v_add_f32_dpp v24, v24, v24 row_ror:8 row_mask:0xf bank_mask:0xf
    v_add_f32_dpp v28, v28, v28 row_ror:8 row_mask:0xf bank_mask:0xf
    v_cvt_pk_bf16_f32 v24, v24, v28
    v_and_b32 v28, 0xffff0000, v24
    v_lshlrev_b32 v24, 16, v24
    v_max_f32 v24, 0, v24
    v_mul_f32 v24, v24, v28
    v_cvt_pk_bf16_f32 v24, v24, v24
    v_lshrrev_b32 v5, 5, v0
    v_lshlrev_b32 v5, 4, v5
    v_lshl_add_u32 v5, v8, 1, v5
    v_add_u32 v5, 163200, v5
    ds_write_b16 v5, v24
    s_mov_b64 exec, 1
    v_mov_b32 v2, 1
    ds_write_b32 v3, v2 offset:24
    s_mov_b64 exec, -1
    s_lshl_b32 s54, s100, 3
    s_add_u32 s54, s54, s101
    s_mul_i32 s53, s54, 7168
    v_lshlrev_b32 v4, 4, v0
    s_mov_b32 m0, 145920
    s_movk_i32 s61, 928
    v_bfe_u32 v7, v0, 2, 2
    v_and_b32 v5, 3, v0
    v_lshlrev_b32 v5, 3, v5
    s_mul_i32 s52, s3, 224
    v_add_u32 v5, s52, v5
    s_movk_i32 s52, 928
    v_mad_u32_u24 v6, v7, s52, v5
    v_add_u32 v6, 145920, v6
    v_lshrrev_b32 v9, 1, v7
    v_and_b32 v7, 1, v7
    v_lshl_or_b32 v9, v9, 2, v7
    v_bfe_u32 v7, v0, 4, 1
    v_lshl_or_b32 v9, v7, 1, v9
    v_mad_u32_u24 v5, v9, s52, v5
    v_add_u32 v5, 131072, v5
    v_mov_b32 v124, 0
    v_mov_b32 v125, 0
    v_mov_b32 v126, 0
    v_mov_b32 v127, 0
    s_cmp_ge_u32 s100, 28
    s_cbranch_scc1 L_nf62
L_sp63:
    ds_read_b32 v2, v3 offset:24
    s_waitcnt lgkmcnt(0)
    v_readfirstlane_b32 s52, v2
    s_cmp_eq_u32 s52, 1
    s_cbranch_scc1 L_sd64
    s_sleep 2
    s_sub_u32 s31, s31, 1
    s_cbranch_scc0 L_sp63
    s_mov_b32 s31, 0
L_sd64:
    v_bfe_u32 v7, v0, 3, 1
    v_lshlrev_b32 v7, 4, v7
    v_add_u32 v7, 163200, v7
    ds_read_b128 v[16:19], v7
    s_mov_b32 s57, 0
    s_waitcnt lgkmcnt(0)
    s_mov_b32 s56, 257
    v_cndmask_b32 v128, 0, v16, s[56:57]
    v_cndmask_b32 v129, 0, v17, s[56:57]
    v_cndmask_b32 v130, 0, v18, s[56:57]
    v_cndmask_b32 v131, 0, v19, s[56:57]
    s_mov_b32 s56, 514
    v_cndmask_b32 v132, 0, v16, s[56:57]
    v_cndmask_b32 v133, 0, v17, s[56:57]
    v_cndmask_b32 v134, 0, v18, s[56:57]
    v_cndmask_b32 v135, 0, v19, s[56:57]
    s_mov_b32 s56, 1028
    v_cndmask_b32 v136, 0, v16, s[56:57]
    v_cndmask_b32 v137, 0, v17, s[56:57]
    v_cndmask_b32 v138, 0, v18, s[56:57]
    v_cndmask_b32 v139, 0, v19, s[56:57]
    s_mov_b32 s56, 2056
    v_cndmask_b32 v140, 0, v16, s[56:57]
    v_cndmask_b32 v141, 0, v17, s[56:57]
    v_cndmask_b32 v142, 0, v18, s[56:57]
    v_cndmask_b32 v143, 0, v19, s[56:57]
    s_mov_b32 s56, 4112
    v_cndmask_b32 v144, 0, v16, s[56:57]
    v_cndmask_b32 v145, 0, v17, s[56:57]
    v_cndmask_b32 v146, 0, v18, s[56:57]
    v_cndmask_b32 v147, 0, v19, s[56:57]
    s_mov_b32 s56, 8224
    v_cndmask_b32 v148, 0, v16, s[56:57]
    v_cndmask_b32 v149, 0, v17, s[56:57]
    v_cndmask_b32 v150, 0, v18, s[56:57]
    v_cndmask_b32 v151, 0, v19, s[56:57]
    s_mov_b32 s56, 16448
    v_cndmask_b32 v152, 0, v16, s[56:57]
    v_cndmask_b32 v153, 0, v17, s[56:57]
    v_cndmask_b32 v154, 0, v18, s[56:57]
    v_cndmask_b32 v155, 0, v19, s[56:57]
L_nf62:
    v_mov_b32 v1, 162944
    v_lshrrev_b32 v7, 4, v0
    v_lshl_add_u32 v1, v7, 4, v1
    v_bfe_u32 v7, v0, 3, 1
    v_mul_u32_u24 v7, 28, v7
    v_add_u32 v7, v7, v8
    s_mul_i32 s52, s3, 7
    v_add_u32 v7, s52, v7
    v_lshrrev_b32 v10, 4, v0
    v_lshl_or_b32 v7, v7, 2, v10
    v_lshrrev_b32 v10, 1, v7
    s_movk_i32 s52, 32
    v_mul_u32_u24 v10, s52, v10
    v_and_b32 v7, 1, v7
    v_lshl_add_u32 v9, v7, 4, v10
    s_mul_i32 s58, s2, 3712
    s_add_u32 s58, s58, 983040
    v_mov_b32 v15, 0xffffff00
    s_mov_b32 s62, 65537
    s_mov_b32 s63, 16777472
    s_mov_b32 s64, 131074
    s_mov_b32 s65, 33554944
    s_mov_b32 s66, 262148
    s_mov_b32 s67, 67109888
    s_mov_b32 s68, 524296
    s_mov_b32 s69, 134219776
    s_mov_b32 s70, 1048592
    s_mov_b32 s71, 268439552
    s_mov_b32 s76, 2097184
    s_mov_b32 s77, 536879104
    s_mov_b32 s54, 4194368
    s_mov_b32 s55, 1073758208
L_sp65:
    ds_read_b32 v2, v3 offset:20
    s_waitcnt lgkmcnt(0)
    v_readfirstlane_b32 s52, v2
    s_cmp_eq_u32 s52, 8
    s_cbranch_scc1 L_sd66
    s_sleep 2
    s_sub_u32 s31, s31, 1
    s_cbranch_scc0 L_sp65
    s_mov_b32 s31, 0
L_sd66:
    s_mov_b32 exec_hi, 0xffffff
    buffer_load_dwordx4 v4, s[48:51], s53 offen nt lds
    s_add_u32 m0, m0, s61
    s_add_u32 s53, s53, 896
    buffer_load_dwordx4 v4, s[48:51], s53 offen nt lds
    s_add_u32 m0, m0, s61
    s_add_u32 s53, s53, 896
    buffer_load_dwordx4 v4, s[48:51], s53 offen nt lds
    s_add_u32 m0, m0, s61
    s_add_u32 s53, s53, 896
    buffer_load_dwordx4 v4, s[48:51], s53 offen nt lds
    s_add_u32 m0, m0, s61
    s_add_u32 s53, s53, 896
    buffer_load_dwordx4 v4, s[48:51], s53 offen nt lds
    s_add_u32 m0, m0, s61
    s_add_u32 s53, s53, 896
    buffer_load_dwordx4 v4, s[48:51], s53 offen nt lds
    s_add_u32 m0, m0, s61
    s_add_u32 s53, s53, 896
    buffer_load_dwordx4 v4, s[48:51], s53 offen nt lds
    s_add_u32 m0, m0, s61
    s_add_u32 s53, s53, 896
    buffer_load_dwordx4 v4, s[48:51], s53 offen nt lds
    s_mov_b64 exec, -1
    s_barrier
    s_waitcnt vmcnt(0)
    s_mov_b64 exec, 1
    v_mov_b32 v2, 1
    ds_write_b32 v3, v2 offset:8
    s_mov_b64 exec, -1
    s_branch L_prep
.p2align 8
L_x23:
    s_lshr_b32 s29, s2, 3
    s_mov_b32 s31, 0x100000
    s_mov_b32 s42, 1073741824
    s_mov_b32 s43, 0x20000
    s_mov_b32 s98, 2097152
    s_mov_b32 s99, 0x20000
    s_movk_i32 s79, 100
    v_mov_b32 v3, 163232
    s_and_b32 s100, s29, 24
    s_add_u32 s100, s100, s28
    s_and_b32 s101, s29, 7
    s_movk_i32 s61, 0x400
L_h23:
    s_cmp_eq_u32 s3, 2
    s_cbranch_scc1 L_h2
    s_waitcnt lgkmcnt(0)
    s_load_dword s30, s[26:27], 0
    s_mov_b64 s[40:41], s[26:27]
    s_mov_b64 s[96:97], s[26:27]
    v_lshlrev_b32 v4, 4, v0
    s_lshl_b32 s54, s28, 5
    s_add_u32 s54, s54, s29
    s_lshl_b32 s55, s54, 9
    s_add_u32 s55, s55, 16384
    s_lshl_b32 s54, s54, 10
    s_add_u32 s54, s54, 147456
    s_lshl_b32 s56, s28, 10
    s_add_u32 s56, s56, 4096
    buffer_load_dwordx4 v[156:159], v4, s[40:43], s54 offen sc1
    buffer_load_dwordx4 v[156:159], v4, s[40:43], s56 offen sc1
    s_mov_b32 exec_hi, 0
    buffer_load_dwordx4 v[156:159], v4, s[40:43], s55 offen sc1
    s_mov_b32 exec_hi, -1
    s_waitcnt lgkmcnt(0)
    s_add_u32 s30, s30, 2654435769
    s_and_b32 s72, s30, 0xff
    s_bfe_u32 s73, s30, 0x80008
    s_bfe_u32 s74, s30, 0x80010
    s_lshr_b32 s75, s30, 24
    s_cmp_lg_u32 s3, 3
    s_cbranch_scc1 L_pre2
    v_and_b32 v5, 15, v0
    v_mov_b32 v6, 163008
    v_lshl_add_u32 v6, v5, 3, v6
    v_lshrrev_b32 v5, 1, v5
    v_mov_b32 v7, 163136
    v_lshl_add_u32 v7, v5, 2, v7
    v_and_b32 v5, 1, v0
    v_lshl_add_u32 v7, v5, 5, v7
    s_lshl_b32 s54, s28, 1
    s_lshr_b32 s55, s29, 4
    s_add_u32 s54, s54, s55
    s_lshl_b32 s54, s54, 9
    s_add_u32 s54, s54, 4096
    s_and_b32 s55, s29, 15
    s_lshl_b32 s55, s55, 5
    s_add_u32 s55, s55, s54
    v_and_b32 v9, 31, v0
    v_lshlrev_b32 v9, 4, v9
    s_mov_b32 s56, 1035512379
    v_mov_b32 v17, s30
    v_mov_b32 v19, s30
L_sp67:
    ds_read_b32 v2, v3 offset:12
    s_waitcnt lgkmcnt(0)
    v_readfirstlane_b32 s52, v2
    s_cmp_eq_u32 s52, 8
    s_cbranch_scc1 L_sd68
    s_sleep 1
    s_sub_u32 s31, s31, 1
    s_cbranch_scc0 L_sp67
    s_mov_b32 s31, 0
L_sd68:
    ds_read_b64 v[10:11], v6
    s_waitcnt lgkmcnt(0)
    v_mov_b32 v16, v10
    s_nop 1
    v_max_f32_dpp v16, v16, v16 row_ror:2 row_mask:0xf bank_mask:0xf
    s_nop 1
    v_max_f32_dpp v16, v16, v16 row_ror:4 row_mask:0xf bank_mask:0xf
    s_nop 1
    v_max_f32_dpp v16, v16, v16 row_ror:8 row_mask:0xf bank_mask:0xf
    v_sub_f32 v18, v10, v16
    v_mul_f32 v18, s56, v18
    v_exp_f32 v12, v18
    s_nop 0
    v_mul_f32 v18, v12, v11
    s_nop 1
    v_add_f32_dpp v18, v18, v18 row_ror:2 row_mask:0xf bank_mask:0xf
    s_nop 1
    v_add_f32_dpp v18, v18, v18 row_ror:4 row_mask:0xf bank_mask:0xf
    s_nop 1
    v_add_f32_dpp v18, v18, v18 row_ror:8 row_mask:0xf bank_mask:0xf
    s_mov_b64 exec, 3
    buffer_store_dwordx4 v[16:19], v9, s[40:43], s55 offen
    s_mov_b64 exec, -1
    s_mov_b64 exec, 0xffff
    ds_write_b32 v7, v12
    s_mov_b64 exec, -1
    s_branch L_pre2
L_h2:
    s_waitcnt lgkmcnt(0)
    s_load_dword s30, s[26:27], 0
    s_mov_b64 s[40:41], s[26:27]
    s_mov_b64 s[96:97], s[26:27]
    s_lshl_b32 s55, s28, 1
    s_lshr_b32 s56, s29, 4
    s_add_u32 s55, s55, s56
    s_lshl_b32 s55, s55, 13
    s_add_u32 s55, s55, 16384
    s_add_u32 s56, s55, 0x1000
    v_lshlrev_b32 v10, 4, v0
    v_mov_b32 v11, 159744
    v_lshl_add_u32 v11, v0, 3, v11
    s_waitcnt lgkmcnt(0)
    s_add_u32 s30, s30, 2654435769
    s_and_b32 s72, s30, 0xff
    s_bfe_u32 s73, s30, 0x80008
    s_bfe_u32 s74, s30, 0x80010
    s_lshr_b32 s75, s30, 24
L_sp71:
    ds_read_b32 v2, v3 offset:16
    s_waitcnt lgkmcnt(0)
    v_readfirstlane_b32 s52, v2
    s_cmp_eq_u32 s52, 1
    s_cbranch_scc1 L_sd72
    s_sleep 2
    s_sub_u32 s31, s31, 1
    s_cbranch_scc0 L_sp71
    s_mov_b32 s31, 0
L_sd72:
L_sp73:
    buffer_load_dwordx4 v[16:19], v10, s[96:99], s55 offen offset:0 sc1
    buffer_load_dwordx4 v[20:23], v10, s[96:99], s55 offen offset:1024 sc1
    buffer_load_dwordx4 v[24:27], v10, s[96:99], s55 offen offset:2048 sc1
    buffer_load_dwordx4 v[28:31], v10, s[96:99], s55 offen offset:3072 sc1
    buffer_load_dwordx4 v[32:35], v10, s[96:99], s56 offen offset:0 sc1
    buffer_load_dwordx4 v[36:39], v10, s[96:99], s56 offen offset:1024 sc1
    buffer_load_dwordx4 v[40:43], v10, s[96:99], s56 offen offset:2048 sc1
    buffer_load_dwordx4 v[44:47], v10, s[96:99], s56 offen offset:3072 sc1
    s_waitcnt vmcnt(0)
    v_xor_b32 v16, s72, v16
    v_xor_b32 v17, s73, v17
    v_xor_b32 v18, s74, v18
    v_xor_b32 v19, s75, v19
    v_xor_b32 v20, s72, v20
    v_xor_b32 v21, s73, v21
    v_xor_b32 v22, s74, v22
    v_xor_b32 v23, s75, v23
    v_xor_b32 v24, s72, v24
    v_xor_b32 v25, s73, v25
    v_xor_b32 v26, s74, v26
    v_xor_b32 v27, s75, v27
    v_xor_b32 v28, s72, v28
    v_xor_b32 v29, s73, v29
    v_xor_b32 v30, s74, v30
    v_xor_b32 v31, s75, v31
    v_xor_b32 v32, s72, v32
    v_xor_b32 v33, s73, v33
    v_xor_b32 v34, s74, v34
    v_xor_b32 v35, s75, v35
    v_xor_b32 v36, s72, v36
    v_xor_b32 v37, s73, v37
    v_xor_b32 v38, s74, v38
    v_xor_b32 v39, s75, v39
    v_xor_b32 v40, s72, v40
    v_xor_b32 v41, s73, v41
    v_xor_b32 v42, s74, v42
    v_xor_b32 v43, s75, v43
    v_xor_b32 v44, s72, v44
    v_xor_b32 v45, s73, v45
    v_xor_b32 v46, s74, v46
    v_xor_b32 v47, s75, v47
    v_or3_b32 v12, v16, v17, v18
    v_or3_b32 v12, v12, v19, v20
    v_or3_b32 v12, v12, v21, v22
    v_or3_b32 v12, v12, v23, v24
    v_or3_b32 v12, v12, v25, v26
    v_or3_b32 v12, v12, v27, v28
    v_or3_b32 v12, v12, v29, v30
    v_or3_b32 v12, v12, v31, v32
    v_or3_b32 v12, v12, v33, v34
    v_or3_b32 v12, v12, v35, v36
    v_or3_b32 v12, v12, v37, v38
    v_or3_b32 v12, v12, v39, v40
    v_or3_b32 v12, v12, v41, v42
    v_or3_b32 v12, v12, v43, v44
    v_or3_b32 v12, v12, v45, v46
    v_or_b32 v12, v12, v47
    v_and_b32 v12, 0xff, v12
    v_cmp_ne_u32 vcc, 0, v12
    s_cbranch_vccz L_sd74
    s_sub_u32 s79, s79, 1
    s_cbranch_scc1 L_mi76
L_sc75:
    s_sleep 1
    s_sub_u32 s31, s31, 64
    s_cbranch_scc0 L_sp73
    s_mov_b32 s31, 0
L_sd74:
    v_pk_add_f32 v[16:17], v[16:17], v[24:25]
    v_pk_add_f32 v[32:33], v[32:33], v[40:41]
    v_pk_add_f32 v[16:17], v[16:17], v[32:33]
    v_cvt_pk_bf16_f32 v12, v16, v17
    v_pk_add_f32 v[18:19], v[18:19], v[26:27]
    v_pk_add_f32 v[34:35], v[34:35], v[42:43]
    v_pk_add_f32 v[18:19], v[18:19], v[34:35]
    v_cvt_pk_bf16_f32 v13, v18, v19
    v_pk_add_f32 v[20:21], v[20:21], v[28:29]
    v_pk_add_f32 v[36:37], v[36:37], v[44:45]
    v_pk_add_f32 v[20:21], v[20:21], v[36:37]
    v_cvt_pk_bf16_f32 v14, v20, v21
    v_pk_add_f32 v[22:23], v[22:23], v[30:31]
    v_pk_add_f32 v[38:39], v[38:39], v[46:47]
    v_pk_add_f32 v[22:23], v[22:23], v[38:39]
    v_cvt_pk_bf16_f32 v15, v22, v23
    ds_write_b64 v11, v[12:13]
    ds_write_b64 v11, v[14:15] offset:576
    s_mov_b64 exec, 1
    v_mov_b32 v2, 1
    ds_write_b32 v3, v2 offset:0
    s_mov_b64 exec, -1
L_pre2:
    v_bfe_u32 v7, v0, 2, 2
    v_and_b32 v5, 3, v0
    v_lshlrev_b32 v5, 3, v5
    s_mul_i32 s52, s3, 224
    v_add_u32 v5, s52, v5
    s_movk_i32 s52, 928
    v_mad_u32_u24 v6, v7, s52, v5
    v_add_u32 v6, 145920, v6
    v_lshrrev_b32 v9, 1, v7
    v_and_b32 v7, 1, v7
    v_lshl_or_b32 v9, v9, 2, v7
    v_bfe_u32 v7, v0, 4, 1
    v_lshl_or_b32 v9, v7, 1, v9
    v_mad_u32_u24 v5, v9, s52, v5
    v_add_u32 v5, 131072, v5
    v_mov_b32 v124, 0
    v_mov_b32 v125, 0
    v_mov_b32 v126, 0
    v_mov_b32 v127, 0
    s_cmp_ge_u32 s100, 28
    s_cbranch_scc1 L_nf77
L_sp78:
    ds_read_b32 v2, v3 offset:24
    s_waitcnt lgkmcnt(0)
    v_readfirstlane_b32 s52, v2
    s_cmp_eq_u32 s52, 1
    s_cbranch_scc1 L_sd79
    s_sleep 2
    s_sub_u32 s31, s31, 1
    s_cbranch_scc0 L_sp78
    s_mov_b32 s31, 0
L_sd79:
    v_bfe_u32 v7, v0, 3, 1
    v_lshlrev_b32 v7, 4, v7
    v_add_u32 v7, 163200, v7
    ds_read_b128 v[16:19], v7
    s_mov_b32 s57, 0
    s_waitcnt lgkmcnt(0)
    s_mov_b32 s56, 257
    v_cndmask_b32 v128, 0, v16, s[56:57]
    v_cndmask_b32 v129, 0, v17, s[56:57]
    v_cndmask_b32 v130, 0, v18, s[56:57]
    v_cndmask_b32 v131, 0, v19, s[56:57]
    s_mov_b32 s56, 514
    v_cndmask_b32 v132, 0, v16, s[56:57]
    v_cndmask_b32 v133, 0, v17, s[56:57]
    v_cndmask_b32 v134, 0, v18, s[56:57]
    v_cndmask_b32 v135, 0, v19, s[56:57]
    s_mov_b32 s56, 1028
    v_cndmask_b32 v136, 0, v16, s[56:57]
    v_cndmask_b32 v137, 0, v17, s[56:57]
    v_cndmask_b32 v138, 0, v18, s[56:57]
    v_cndmask_b32 v139, 0, v19, s[56:57]
    s_mov_b32 s56, 2056
    v_cndmask_b32 v140, 0, v16, s[56:57]
    v_cndmask_b32 v141, 0, v17, s[56:57]
    v_cndmask_b32 v142, 0, v18, s[56:57]
    v_cndmask_b32 v143, 0, v19, s[56:57]
    s_mov_b32 s56, 4112
    v_cndmask_b32 v144, 0, v16, s[56:57]
    v_cndmask_b32 v145, 0, v17, s[56:57]
    v_cndmask_b32 v146, 0, v18, s[56:57]
    v_cndmask_b32 v147, 0, v19, s[56:57]
    s_mov_b32 s56, 8224
    v_cndmask_b32 v148, 0, v16, s[56:57]
    v_cndmask_b32 v149, 0, v17, s[56:57]
    v_cndmask_b32 v150, 0, v18, s[56:57]
    v_cndmask_b32 v151, 0, v19, s[56:57]
    s_mov_b32 s56, 16448
    v_cndmask_b32 v152, 0, v16, s[56:57]
    v_cndmask_b32 v153, 0, v17, s[56:57]
    v_cndmask_b32 v154, 0, v18, s[56:57]
    v_cndmask_b32 v155, 0, v19, s[56:57]
L_nf77:
    v_mov_b32 v1, 162944
    v_lshrrev_b32 v7, 4, v0
    v_lshl_add_u32 v1, v7, 4, v1
    v_bfe_u32 v7, v0, 3, 1
    v_mul_u32_u24 v7, 28, v7
    v_add_u32 v7, v7, v8
    s_mul_i32 s52, s3, 7
    v_add_u32 v7, s52, v7
    v_lshrrev_b32 v10, 4, v0
    v_lshl_or_b32 v7, v7, 2, v10
    v_lshrrev_b32 v10, 1, v7
    s_movk_i32 s52, 32
    v_mul_u32_u24 v10, s52, v10
    v_and_b32 v7, 1, v7
    v_lshl_add_u32 v9, v7, 4, v10
    s_mul_i32 s58, s2, 3712
    s_add_u32 s58, s58, 983040
    v_mov_b32 v15, 0xffffff00
    s_mov_b32 s62, 65537
    s_mov_b32 s63, 16777472
    s_mov_b32 s64, 131074
    s_mov_b32 s65, 33554944
    s_mov_b32 s66, 262148
    s_mov_b32 s67, 67109888
    s_mov_b32 s68, 524296
    s_mov_b32 s69, 134219776
    s_mov_b32 s70, 1048592
    s_mov_b32 s71, 268439552
    s_mov_b32 s76, 2097184
    s_mov_b32 s77, 536879104
    s_mov_b32 s54, 4194368
    s_mov_b32 s55, 1073758208
    s_waitcnt lgkmcnt(0)
    s_barrier
L_prep:
    s_setprio 1
    s_cmp_ge_u32 s100, 28
    s_cbranch_scc1 L_noffn
L_sp80:
    ds_read_b32 v2, v3 offset:8
    s_waitcnt lgkmcnt(0)
    v_readfirstlane_b32 s52, v2
    s_cmp_eq_u32 s52, 1
    s_cbranch_scc1 L_sd81
    s_sleep 0
    s_sub_u32 s31, s31, 1
    s_cbranch_scc0 L_sp80
    s_mov_b32 s31, 0
L_sd81:
    ds_read_b64_tr_b16 v[64:65], v6 offset:0
    ds_read_b64_tr_b16 v[66:67], v6 offset:3712
    ds_read_b64_tr_b16 v[68:69], v6 offset:32
    ds_read_b64_tr_b16 v[70:71], v6 offset:3744
    ds_read_b64_tr_b16 v[72:73], v6 offset:64
    ds_read_b64_tr_b16 v[74:75], v6 offset:3776
    ds_read_b64_tr_b16 v[76:77], v6 offset:96
    ds_read_b64_tr_b16 v[78:79], v6 offset:3808
    ds_read_b64_tr_b16 v[80:81], v6 offset:128
    ds_read_b64_tr_b16 v[82:83], v6 offset:3840
    ds_read_b64_tr_b16 v[84:85], v6 offset:160
    ds_read_b64_tr_b16 v[86:87], v6 offset:3872
    ds_read_b64_tr_b16 v[88:89], v6 offset:192
    ds_read_b64_tr_b16 v[90:91], v6 offset:3904
    s_waitcnt lgkmcnt(12)
    v_mfma_f32_16x16x32_bf16 v[124:127], v[64:67], v[128:131], v[124:127]
    s_waitcnt lgkmcnt(10)
    v_mfma_f32_16x16x32_bf16 v[124:127], v[68:71], v[132:135], v[124:127]
    s_waitcnt lgkmcnt(8)
    v_mfma_f32_16x16x32_bf16 v[124:127], v[72:75], v[136:139], v[124:127]
    s_waitcnt lgkmcnt(6)
    v_mfma_f32_16x16x32_bf16 v[124:127], v[76:79], v[140:143], v[124:127]
    s_waitcnt lgkmcnt(4)
    v_mfma_f32_16x16x32_bf16 v[124:127], v[80:83], v[144:147], v[124:127]
    s_waitcnt lgkmcnt(2)
    v_mfma_f32_16x16x32_bf16 v[124:127], v[84:87], v[148:151], v[124:127]
    s_waitcnt lgkmcnt(0)
    v_mfma_f32_16x16x32_bf16 v[124:127], v[88:91], v[152:155], v[124:127]
L_noffn:
    s_cmp_lg_u32 s3, 0
    s_cbranch_scc1 L_nw0
    s_waitcnt vmcnt(0)
    s_mov_b64 exec, 1
    v_mov_b32 v2, 1
    ds_write_b32 v3, v2 offset:4
    s_mov_b64 exec, -1
L_nw0:
L_sp82:
    ds_read_b32 v2, v3 offset:4
    s_waitcnt lgkmcnt(0)
    v_readfirstlane_b32 s52, v2
    s_cmp_eq_u32 s52, 1
    s_cbranch_scc1 L_sd83
    s_sleep 0
    s_sub_u32 s31, s31, 1
    s_cbranch_scc0 L_sp82
    s_mov_b32 s31, 0
L_sd83:
    ds_read_b64_tr_b16 v[32:33], v5 offset:0
    ds_read_b64_tr_b16 v[34:35], v5 offset:7424
    ds_read_b64_tr_b16 v[36:37], v5 offset:32
    ds_read_b64_tr_b16 v[38:39], v5 offset:7456
    ds_read_b64_tr_b16 v[40:41], v5 offset:64
    ds_read_b64_tr_b16 v[42:43], v5 offset:7488
    ds_read_b64_tr_b16 v[44:45], v5 offset:96
    ds_read_b64_tr_b16 v[46:47], v5 offset:7520
    ds_read_b64_tr_b16 v[48:49], v5 offset:128
    ds_read_b64_tr_b16 v[50:51], v5 offset:7552
    ds_read_b64_tr_b16 v[52:53], v5 offset:160
    ds_read_b64_tr_b16 v[54:55], v5 offset:7584
    ds_read_b64_tr_b16 v[56:57], v5 offset:192
    ds_read_b64_tr_b16 v[58:59], v5 offset:7616
    s_barrier
    ds_read_b128 v[16:19], v1
    s_waitcnt lgkmcnt(0)
    v_cndmask_b32 v96, 0, v16, s[62:63]
    v_cndmask_b32 v97, 0, v17, s[62:63]
    v_cndmask_b32 v98, 0, v18, s[62:63]
    v_cndmask_b32 v99, 0, v19, s[62:63]
    v_cndmask_b32 v100, 0, v16, s[64:65]
    v_cndmask_b32 v101, 0, v17, s[64:65]
    v_cndmask_b32 v102, 0, v18, s[64:65]
    v_cndmask_b32 v103, 0, v19, s[64:65]
    v_mfma_f32_16x16x32_bf16 v[124:127], v[32:35], v[96:99], v[124:127]
    v_cndmask_b32 v104, 0, v16, s[66:67]
    v_cndmask_b32 v105, 0, v17, s[66:67]
    v_cndmask_b32 v106, 0, v18, s[66:67]
    v_cndmask_b32 v107, 0, v19, s[66:67]
    v_mfma_f32_16x16x32_bf16 v[124:127], v[36:39], v[100:103], v[124:127]
    v_cndmask_b32 v108, 0, v16, s[68:69]
    v_cndmask_b32 v109, 0, v17, s[68:69]
    v_cndmask_b32 v110, 0, v18, s[68:69]
    v_cndmask_b32 v111, 0, v19, s[68:69]
    v_mfma_f32_16x16x32_bf16 v[124:127], v[40:43], v[104:107], v[124:127]
    v_cndmask_b32 v112, 0, v16, s[70:71]
    v_cndmask_b32 v113, 0, v17, s[70:71]
    v_cndmask_b32 v114, 0, v18, s[70:71]
    v_cndmask_b32 v115, 0, v19, s[70:71]
    v_mfma_f32_16x16x32_bf16 v[124:127], v[44:47], v[108:111], v[124:127]
    v_cndmask_b32 v116, 0, v16, s[76:77]
    v_cndmask_b32 v117, 0, v17, s[76:77]
    v_cndmask_b32 v118, 0, v18, s[76:77]
    v_cndmask_b32 v119, 0, v19, s[76:77]
    v_mfma_f32_16x16x32_bf16 v[124:127], v[48:51], v[112:115], v[124:127]
    v_cndmask_b32 v120, 0, v16, s[54:55]
    v_cndmask_b32 v121, 0, v17, s[54:55]
    v_cndmask_b32 v122, 0, v18, s[54:55]
    v_cndmask_b32 v123, 0, v19, s[54:55]
    v_mfma_f32_16x16x32_bf16 v[124:127], v[52:55], v[116:119], v[124:127]
    s_nop 0
    v_mfma_f32_16x16x32_bf16 v[124:127], v[56:59], v[120:123], v[124:127]
    s_nop 7
    v_and_or_b32 v124, v124, v15, s72
    v_and_or_b32 v125, v125, v15, s73
    v_and_or_b32 v126, v126, v15, s74
    v_and_or_b32 v127, v127, v15, s75
    s_mov_b32 exec_lo, 0x7f7f7f7f
    s_mov_b32 exec_hi, 0x7f7f7f7f
    buffer_store_dwordx4 v[124:127], v9, s[40:43], s58 offen sc1
    s_cmp_lg_u32 s3, 3
    s_cbranch_scc1 L_npad
    s_mov_b64 exec, 1
    v_mov_b32 v9, 3584
    buffer_store_dwordx4 v[124:127], v9, s[40:43], s58 offen sc1
L_npad:
    s_mov_b64 exec, -1
    s_barrier
    s_endpgm
L_exit:
    s_endpgm
L_watch:
    s_cmp_lg_u32 s53, 4
    s_cbranch_scc1 L_fin
    v_and_b32 v5, 31, v0
    v_lshl_add_u32 v5, v5, 3, s28
    s_movk_i32 s52, 3712
    v_mul_u32_u24 v5, s52, v5
    s_movk_i32 s70, 3584
    s_add_u32 s70, s70, 983040
    s_barrier
    s_barrier
    s_sleep 24
    s_mov_b64 vcc, 0xffffffff
L_sp84:
    s_mov_b64 exec, vcc
    buffer_load_dwordx4 v[16:19], v5, s[40:43], s70 offen sc1
    s_waitcnt vmcnt(0)
    v_xor_b32 v12, s72, v16
    v_bitop3_b32 v12, v12, v17, s73 bitop3:0xf6
    v_bitop3_b32 v12, v12, v18, s74 bitop3:0xf6
    v_bitop3_b32 v12, v12, v19, s75 bitop3:0xf6
    v_and_b32 v12, 0xff, v12
    v_cmp_ne_u32 vcc, 0, v12
    s_cbranch_vccz L_sd85
    s_sub_u32 s79, s79, 1
    s_cbranch_scc1 L_mi87
L_sc86:
    s_sleep 2
    s_sub_u32 s31, s31, 64
    s_cbranch_scc0 L_sp84
    s_mov_b32 s31, 0
L_sd85:
    s_branch L_fin
L_mi44:
    s_add_u32 s96, s40, 2097152
    s_addc_u32 s97, s41, 0
    s_mov_b32 s79, 0
    s_mov_b64 exec, -1
    v_lshlrev_b32 v155, 4, v0
    s_lshl_b32 s52, s28, 5
    s_add_u32 s52, s52, s29
    s_lshl_b32 s52, s52, 10
    s_add_u32 s52, s52, 147456
    buffer_load_dwordx4 v[156:159], v155, s[40:43], s52 offen offset:0 sc1
    s_waitcnt vmcnt(0)
    buffer_store_dwordx4 v[156:159], v155, s[96:99], s52 offen offset:0 sc1
    s_waitcnt vmcnt(0)
    s_lshl_b32 s52, s28, 5
    s_add_u32 s52, s52, s29
    s_mulk_i32 s52, 2176
    s_add_u32 s52, s52, 409600
    buffer_load_dwordx4 v[156:159], v155, s[40:43], s52 offen offset:0 sc1
    s_waitcnt vmcnt(0)
    buffer_store_dwordx4 v[156:159], v155, s[96:99], s52 offen offset:0 sc1
    s_waitcnt vmcnt(0)
    s_nop 0
    buffer_load_dwordx4 v[156:159], v155, s[40:43], s52 offen offset:1024 sc1
    s_waitcnt vmcnt(0)
    buffer_store_dwordx4 v[156:159], v155, s[96:99], s52 offen offset:1024 sc1
    s_waitcnt vmcnt(0)
    s_mov_b64 exec, 3
    s_lshl_b32 s52, s28, 5
    s_add_u32 s52, s52, s29
    s_lshl_b32 s52, s52, 5
    s_add_u32 s52, s52, 4096
    buffer_load_dwordx4 v[156:159], v155, s[40:43], s52 offen offset:0 sc1
    s_waitcnt vmcnt(0)
    buffer_store_dwordx4 v[156:159], v155, s[96:99], s52 offen offset:0 sc1
    s_waitcnt vmcnt(0)
    s_mov_b64 exec, 0xffff
    s_lshl_b32 s52, s28, 6
    s_add_u32 s52, s52, s29
    s_lshl_b32 s52, s52, 8
    s_add_u32 s52, s52, 16384
    buffer_load_dwordx4 v[156:159], v155, s[40:43], s52 offen offset:0 sc1
    s_waitcnt vmcnt(0)
    buffer_store_dwordx4 v[156:159], v155, s[96:99], s52 offen offset:0 sc1
    s_waitcnt vmcnt(0)
    s_addk_i32 s52, 0x2000
    buffer_load_dwordx4 v[156:159], v155, s[40:43], s52 offen offset:0 sc1
    s_waitcnt vmcnt(0)
    buffer_store_dwordx4 v[156:159], v155, s[96:99], s52 offen offset:0 sc1
    s_waitcnt vmcnt(0)
    s_mov_b64 exec, -1
    s_branch L_sc43
L_mi48:
    s_add_u32 s96, s40, 2097152
    s_addc_u32 s97, s41, 0
    s_mov_b32 s79, 0
    s_mov_b64 exec, -1
    v_lshlrev_b32 v155, 4, v0
    s_lshl_b32 s52, s28, 5
    s_add_u32 s52, s52, s29
    s_lshl_b32 s52, s52, 10
    s_add_u32 s52, s52, 147456
    buffer_load_dwordx4 v[156:159], v155, s[40:43], s52 offen offset:0 sc1
    s_waitcnt vmcnt(0)
    buffer_store_dwordx4 v[156:159], v155, s[96:99], s52 offen offset:0 sc1
    s_waitcnt vmcnt(0)
    s_lshl_b32 s52, s28, 5
    s_add_u32 s52, s52, s29
    s_mulk_i32 s52, 2176
    s_add_u32 s52, s52, 409600
    buffer_load_dwordx4 v[156:159], v155, s[40:43], s52 offen offset:0 sc1
    s_waitcnt vmcnt(0)
    buffer_store_dwordx4 v[156:159], v155, s[96:99], s52 offen offset:0 sc1
    s_waitcnt vmcnt(0)
    s_nop 0
    buffer_load_dwordx4 v[156:159], v155, s[40:43], s52 offen offset:1024 sc1
    s_waitcnt vmcnt(0)
    buffer_store_dwordx4 v[156:159], v155, s[96:99], s52 offen offset:1024 sc1
    s_waitcnt vmcnt(0)
    s_mov_b64 exec, 3
    s_lshl_b32 s52, s28, 5
    s_add_u32 s52, s52, s29
    s_lshl_b32 s52, s52, 5
    s_add_u32 s52, s52, 4096
    buffer_load_dwordx4 v[156:159], v155, s[40:43], s52 offen offset:0 sc1
    s_waitcnt vmcnt(0)
    buffer_store_dwordx4 v[156:159], v155, s[96:99], s52 offen offset:0 sc1
    s_waitcnt vmcnt(0)
    s_mov_b64 exec, 0xffff
    s_lshl_b32 s52, s28, 6
    s_add_u32 s52, s52, s29
    s_lshl_b32 s52, s52, 8
    s_add_u32 s52, s52, 16384
    buffer_load_dwordx4 v[156:159], v155, s[40:43], s52 offen offset:0 sc1
    s_waitcnt vmcnt(0)
    buffer_store_dwordx4 v[156:159], v155, s[96:99], s52 offen offset:0 sc1
    s_waitcnt vmcnt(0)
    s_addk_i32 s52, 0x2000
    buffer_load_dwordx4 v[156:159], v155, s[40:43], s52 offen offset:0 sc1
    s_waitcnt vmcnt(0)
    buffer_store_dwordx4 v[156:159], v155, s[96:99], s52 offen offset:0 sc1
    s_waitcnt vmcnt(0)
    s_mov_b64 exec, -1
    s_branch L_sc47
L_mi52:
    s_add_u32 s96, s40, 2097152
    s_addc_u32 s97, s41, 0
    s_mov_b32 s79, 0
    s_mov_b64 exec, -1
    v_lshlrev_b32 v155, 4, v0
    s_lshl_b32 s52, s28, 5
    s_add_u32 s52, s52, s29
    s_lshl_b32 s52, s52, 10
    s_add_u32 s52, s52, 147456
    buffer_load_dwordx4 v[156:159], v155, s[40:43], s52 offen offset:0 sc1
    s_waitcnt vmcnt(0)
    buffer_store_dwordx4 v[156:159], v155, s[96:99], s52 offen offset:0 sc1
    s_waitcnt vmcnt(0)
    s_lshl_b32 s52, s28, 5
    s_add_u32 s52, s52, s29
    s_mulk_i32 s52, 2176
    s_add_u32 s52, s52, 409600
    buffer_load_dwordx4 v[156:159], v155, s[40:43], s52 offen offset:0 sc1
    s_waitcnt vmcnt(0)
    buffer_store_dwordx4 v[156:159], v155, s[96:99], s52 offen offset:0 sc1
    s_waitcnt vmcnt(0)
    s_nop 0
    buffer_load_dwordx4 v[156:159], v155, s[40:43], s52 offen offset:1024 sc1
    s_waitcnt vmcnt(0)
    buffer_store_dwordx4 v[156:159], v155, s[96:99], s52 offen offset:1024 sc1
    s_waitcnt vmcnt(0)
    s_mov_b64 exec, 3
    s_lshl_b32 s52, s28, 5
    s_add_u32 s52, s52, s29
    s_lshl_b32 s52, s52, 5
    s_add_u32 s52, s52, 4096
    buffer_load_dwordx4 v[156:159], v155, s[40:43], s52 offen offset:0 sc1
    s_waitcnt vmcnt(0)
    buffer_store_dwordx4 v[156:159], v155, s[96:99], s52 offen offset:0 sc1
    s_waitcnt vmcnt(0)
    s_mov_b64 exec, 0xffff
    s_lshl_b32 s52, s28, 6
    s_add_u32 s52, s52, s29
    s_lshl_b32 s52, s52, 8
    s_add_u32 s52, s52, 16384
    buffer_load_dwordx4 v[156:159], v155, s[40:43], s52 offen offset:0 sc1
    s_waitcnt vmcnt(0)
    buffer_store_dwordx4 v[156:159], v155, s[96:99], s52 offen offset:0 sc1
    s_waitcnt vmcnt(0)
    s_addk_i32 s52, 0x2000
    buffer_load_dwordx4 v[156:159], v155, s[40:43], s52 offen offset:0 sc1
    s_waitcnt vmcnt(0)
    buffer_store_dwordx4 v[156:159], v155, s[96:99], s52 offen offset:0 sc1
    s_waitcnt vmcnt(0)
    s_mov_b64 exec, -1
    s_branch L_sc51
L_mi61:
    s_add_u32 s96, s40, 2097152
    s_addc_u32 s97, s41, 0
    s_mov_b32 s79, 0
    s_mov_b64 exec, -1
    v_lshlrev_b32 v155, 4, v0
    s_lshl_b32 s52, s28, 5
    s_add_u32 s52, s52, s29
    s_lshl_b32 s52, s52, 10
    s_add_u32 s52, s52, 147456
    buffer_load_dwordx4 v[156:159], v155, s[40:43], s52 offen offset:0 sc1
    s_waitcnt vmcnt(0)
    buffer_store_dwordx4 v[156:159], v155, s[96:99], s52 offen offset:0 sc1
    s_waitcnt vmcnt(0)
    s_lshl_b32 s52, s28, 5
    s_add_u32 s52, s52, s29
    s_mulk_i32 s52, 2176
    s_add_u32 s52, s52, 409600
    buffer_load_dwordx4 v[156:159], v155, s[40:43], s52 offen offset:0 sc1
    s_waitcnt vmcnt(0)
    buffer_store_dwordx4 v[156:159], v155, s[96:99], s52 offen offset:0 sc1
    s_waitcnt vmcnt(0)
    s_nop 0
    buffer_load_dwordx4 v[156:159], v155, s[40:43], s52 offen offset:1024 sc1
    s_waitcnt vmcnt(0)
    buffer_store_dwordx4 v[156:159], v155, s[96:99], s52 offen offset:1024 sc1
    s_waitcnt vmcnt(0)
    s_mov_b64 exec, 3
    s_lshl_b32 s52, s28, 5
    s_add_u32 s52, s52, s29
    s_lshl_b32 s52, s52, 5
    s_add_u32 s52, s52, 4096
    buffer_load_dwordx4 v[156:159], v155, s[40:43], s52 offen offset:0 sc1
    s_waitcnt vmcnt(0)
    buffer_store_dwordx4 v[156:159], v155, s[96:99], s52 offen offset:0 sc1
    s_waitcnt vmcnt(0)
    s_mov_b64 exec, 0xffff
    s_lshl_b32 s52, s28, 6
    s_add_u32 s52, s52, s29
    s_lshl_b32 s52, s52, 8
    s_add_u32 s52, s52, 16384
    buffer_load_dwordx4 v[156:159], v155, s[40:43], s52 offen offset:0 sc1
    s_waitcnt vmcnt(0)
    buffer_store_dwordx4 v[156:159], v155, s[96:99], s52 offen offset:0 sc1
    s_waitcnt vmcnt(0)
    s_addk_i32 s52, 0x2000
    buffer_load_dwordx4 v[156:159], v155, s[40:43], s52 offen offset:0 sc1
    s_waitcnt vmcnt(0)
    buffer_store_dwordx4 v[156:159], v155, s[96:99], s52 offen offset:0 sc1
    s_waitcnt vmcnt(0)
    s_mov_b64 exec, -1
    s_branch L_sc60
L_mi76:
    s_add_u32 s96, s40, 2097152
    s_addc_u32 s97, s41, 0
    s_mov_b32 s79, 0
    s_mov_b64 exec, -1
    v_lshlrev_b32 v155, 4, v0
    s_lshl_b32 s52, s28, 5
    s_add_u32 s52, s52, s29
    s_lshl_b32 s52, s52, 10
    s_add_u32 s52, s52, 147456
    buffer_load_dwordx4 v[156:159], v155, s[40:43], s52 offen offset:0 sc1
    s_waitcnt vmcnt(0)
    buffer_store_dwordx4 v[156:159], v155, s[96:99], s52 offen offset:0 sc1
    s_waitcnt vmcnt(0)
    s_lshl_b32 s52, s28, 5
    s_add_u32 s52, s52, s29
    s_mulk_i32 s52, 2176
    s_add_u32 s52, s52, 409600
    buffer_load_dwordx4 v[156:159], v155, s[40:43], s52 offen offset:0 sc1
    s_waitcnt vmcnt(0)
    buffer_store_dwordx4 v[156:159], v155, s[96:99], s52 offen offset:0 sc1
    s_waitcnt vmcnt(0)
    s_nop 0
    buffer_load_dwordx4 v[156:159], v155, s[40:43], s52 offen offset:1024 sc1
    s_waitcnt vmcnt(0)
    buffer_store_dwordx4 v[156:159], v155, s[96:99], s52 offen offset:1024 sc1
    s_waitcnt vmcnt(0)
    s_mov_b64 exec, 3
    s_lshl_b32 s52, s28, 5
    s_add_u32 s52, s52, s29
    s_lshl_b32 s52, s52, 5
    s_add_u32 s52, s52, 4096
    buffer_load_dwordx4 v[156:159], v155, s[40:43], s52 offen offset:0 sc1
    s_waitcnt vmcnt(0)
    buffer_store_dwordx4 v[156:159], v155, s[96:99], s52 offen offset:0 sc1
    s_waitcnt vmcnt(0)
    s_mov_b64 exec, 0xffff
    s_lshl_b32 s52, s28, 6
    s_add_u32 s52, s52, s29
    s_lshl_b32 s52, s52, 8
    s_add_u32 s52, s52, 16384
    buffer_load_dwordx4 v[156:159], v155, s[40:43], s52 offen offset:0 sc1
    s_waitcnt vmcnt(0)
    buffer_store_dwordx4 v[156:159], v155, s[96:99], s52 offen offset:0 sc1
    s_waitcnt vmcnt(0)
    s_addk_i32 s52, 0x2000
    buffer_load_dwordx4 v[156:159], v155, s[40:43], s52 offen offset:0 sc1
    s_waitcnt vmcnt(0)
    buffer_store_dwordx4 v[156:159], v155, s[96:99], s52 offen offset:0 sc1
    s_waitcnt vmcnt(0)
    s_mov_b64 exec, -1
    s_branch L_sc75
L_mi87:
    s_add_u32 s96, s40, 2097152
    s_addc_u32 s97, s41, 0
    s_mov_b32 s79, 0
    s_mov_b64 exec, -1
    v_lshlrev_b32 v155, 4, v0
    s_lshl_b32 s52, s28, 5
    s_add_u32 s52, s52, s29
    s_lshl_b32 s52, s52, 10
    s_add_u32 s52, s52, 147456
    buffer_load_dwordx4 v[156:159], v155, s[40:43], s52 offen offset:0 sc1
    s_waitcnt vmcnt(0)
    buffer_store_dwordx4 v[156:159], v155, s[96:99], s52 offen offset:0 sc1
    s_waitcnt vmcnt(0)
    s_lshl_b32 s52, s28, 5
    s_add_u32 s52, s52, s29
    s_mulk_i32 s52, 2176
    s_add_u32 s52, s52, 409600
    buffer_load_dwordx4 v[156:159], v155, s[40:43], s52 offen offset:0 sc1
    s_waitcnt vmcnt(0)
    buffer_store_dwordx4 v[156:159], v155, s[96:99], s52 offen offset:0 sc1
    s_waitcnt vmcnt(0)
    s_nop 0
    buffer_load_dwordx4 v[156:159], v155, s[40:43], s52 offen offset:1024 sc1
    s_waitcnt vmcnt(0)
    buffer_store_dwordx4 v[156:159], v155, s[96:99], s52 offen offset:1024 sc1
    s_waitcnt vmcnt(0)
    s_mov_b64 exec, 3
    s_lshl_b32 s52, s28, 5
    s_add_u32 s52, s52, s29
    s_lshl_b32 s52, s52, 5
    s_add_u32 s52, s52, 4096
    buffer_load_dwordx4 v[156:159], v155, s[40:43], s52 offen offset:0 sc1
    s_waitcnt vmcnt(0)
    buffer_store_dwordx4 v[156:159], v155, s[96:99], s52 offen offset:0 sc1
    s_waitcnt vmcnt(0)
    s_mov_b64 exec, 0xffff
    s_lshl_b32 s52, s28, 6
    s_add_u32 s52, s52, s29
    s_lshl_b32 s52, s52, 8
    s_add_u32 s52, s52, 16384
    buffer_load_dwordx4 v[156:159], v155, s[40:43], s52 offen offset:0 sc1
    s_waitcnt vmcnt(0)
    buffer_store_dwordx4 v[156:159], v155, s[96:99], s52 offen offset:0 sc1
    s_waitcnt vmcnt(0)
    s_addk_i32 s52, 0x2000
    buffer_load_dwordx4 v[156:159], v155, s[40:43], s52 offen offset:0 sc1
    s_waitcnt vmcnt(0)
    buffer_store_dwordx4 v[156:159], v155, s[96:99], s52 offen offset:0 sc1
    s_waitcnt vmcnt(0)
    s_mov_b64 exec, -1
    s_branch L_sc86
.section .rodata,"a"
.p2align 6
.amdhsa_kernel parallel_sum__sliding_block_cached__glu_gated_reglu__decode_kernel
  .amdhsa_next_free_vgpr 160
  .amdhsa_next_free_sgpr 102
  .amdhsa_accum_offset 160
  .amdhsa_group_segment_fixed_size 0
  .amdhsa_kernarg_size 96
  .amdhsa_user_sgpr_count 2
  .amdhsa_user_sgpr_kernarg_segment_ptr 1
  .amdhsa_system_sgpr_workgroup_id_x 1
.end_amdhsa_kernel
```
